```python
import torch

def _softmax(x, axis=-1):
    return torch.softmax(x, dim=axis)
def _gelu(x):
    return torch.nn.functional.gelu(x, approximate="tanh")
def _silu(x):
    return torch.nn.functional.silu(x)
def _sigmoid(x):
    return torch.sigmoid(x)
def _layernorm(x, axis=-1, eps=1e-5):
    m = x.mean(dim=axis, keepdim=True)
    v = x.var(dim=axis, keepdim=True, unbiased=False)
    return (x - m) / torch.sqrt(v + eps)
def _scatter_add(tgt, idx, src, axis=0):
    return tgt.clone().index_add_(axis, idx, src)
def _segment_sum(src, seg, n):
    out = torch.zeros((n,) + src.shape[1:], dtype=src.dtype)
    return out.index_add_(0, seg, src)
def _pad(x, pw):
    flat = tuple(v for pair in reversed(pw) for v in pair)
    return torch.nn.functional.pad(x, flat)

kernel_name = 'recurrent_scan__gqa_block_cached__swiglu_ffn__decode'

def setup_inputs():

    _w = (lambda a: (lambda t: t.to(torch.bfloat16) if t.is_floating_point() else t)(torch.as_tensor(a)))
    def _A_setup():
        B, Sq, D = 2, 1, 448
        Hq, Hkv, Sk, Dh = 16, 8, 32768, 256
        assert Hq % Hkv == 0, (Hq, Hkv)
        return {
            "x": _w((lambda *s: torch.randn(*s, dtype=torch.bfloat16) * 0.05)(B, Sq, D)),
            "k_cache": _w((lambda *s: torch.randn(*s, dtype=torch.bfloat16) * 0.8)(B, Hkv, Sk, Dh)),
            "v_cache": _w((lambda *s: torch.randn(*s, dtype=torch.bfloat16) * 0.8)(B, Hkv, Sk, Dh)),
            "wq": _w((lambda *s: torch.randn(*s, dtype=torch.bfloat16) * 0.8)(D, Hq * Dh) * (D ** -0.5)),
            "wo": _w((lambda *s: torch.randn(*s, dtype=torch.bfloat16) * 0.8)(Hq * Dh, D) * ((Hq * Dh) ** -0.5)),
        }
    _A_in = _A_setup()

    def _B_setup():
        B, S, D, F = 2, 1, 448, 1792
        return {
            "x": _w((lambda *s: torch.randn(*s, dtype=torch.bfloat16) * 0.05)(B, S, D)),
            "w_gate": _w((lambda *s: torch.randn(*s, dtype=torch.bfloat16) * 0.2)(D, F)),
            "w_up": _w((lambda *s: torch.randn(*s, dtype=torch.bfloat16) * 0.2)(D, F)),
            "w_down": _w((lambda *s: torch.randn(*s, dtype=torch.bfloat16) * 0.2)(F, D)),
        }
    _B_in = _B_setup()

    return {
        "A_x": _A_in["x"],
        "A_k_cache": _A_in["k_cache"],
        "A_v_cache": _A_in["v_cache"],
        "A_wq": _A_in["wq"],
        "A_wo": _A_in["wo"],
        "B_x": _B_in["x"],
        "B_w_gate": _B_in["w_gate"],
        "B_w_up": _B_in["w_up"],
        "B_w_down": _B_in["w_down"],
    }

def reference(A_x, A_k_cache, A_v_cache, A_wq, A_wo, B_x, B_w_gate, B_w_up, B_w_down):
    def _A_ref(x, k_cache, v_cache, wq, wo):
        B, Sq, D = x.shape
        Hq, Dh = 16, 256
        Hkv = k_cache.shape[1]
        rep = Hq // Hkv
        q = (lambda x, *d: x.permute(*d))((x @ wq).reshape(B, Sq, Hq, Dh), 0, 2, 1, 3)
        k = (lambda x, n, axis: torch.repeat_interleave(x, n, dim=axis))(k_cache, rep, axis=1)
        v = (lambda x, n, axis: torch.repeat_interleave(x, n, dim=axis))(v_cache, rep, axis=1)
        scores = torch.einsum("bhqd,bhkd->bhqk", q, k) * (Dh ** -0.5)
        p = _softmax(scores, axis=-1)
        o = torch.einsum("bhqk,bhkd->bhqd", p, v)
        return (lambda x, *d: x.permute(*d))(o, 0, 2, 1, 3).reshape(B, Sq, Hq * Dh) @ wo

    def _B_ref(x, w_gate, w_up, w_down):
        g = _silu(x @ w_gate)
        u = x @ w_up
        return (g * u) @ w_down

    x = A_x
    xn = _layernorm(x, axis=-1)
    s = _A_ref(xn, A_k_cache, A_v_cache, A_wq, A_wo)
    g = _silu(_B_ref(xn, B_w_gate, B_w_up, B_w_down))
    return x + s * g
```

```asm
; @launch grid=(256,1,1) block=(512,1,1) lds=74752
.amdgcn_target "amdgcn-amd-amdhsa--gfx950"
.text
.globl recurrent_scan__gqa_block_cached__swiglu_ffn__decode_kernel
.p2align 8
.type recurrent_scan__gqa_block_cached__swiglu_ffn__decode_kernel,@function
recurrent_scan__gqa_block_cached__swiglu_ffn__decode_kernel:
    s_cmp_ge_u32 s2, 256
    s_cbranch_scc1 L_end
    s_load_dwordx16 s[16:31], s[0:1], 0
    s_load_dwordx8 s[32:39], s[0:1], 64
    v_lshrrev_b32 v1, 6, v0
    v_and_b32 v0, 63, v0
    v_readfirstlane_b32 s3, v1
    s_nop 1
    s_cmp_lg_u32 s3, 7
    s_cbranch_scc1 L_noipf
    s_getpc_b64 s[8:9]
    s_and_b32 s8, s8, 0xffffff00
    s_lshr_b32 s10, s2, 3
    s_mul_i32 s10, s10, 640
    v_lshl_add_u32 v3, v0, 7, s10
    s_mov_b64 exec, 31
    global_load_dword v4, v3, s[8:9]
    s_mov_b64 exec, -1
L_noipf:
    v_and_b32 v1, 15, v0
    v_lshrrev_b32 v2, 4, v0
    s_and_b32 s6, s2, 3
    s_lshr_b32 s7, s2, 2
    s_mov_b32 s83, 0xbfb8aa3b
    s_mov_b32 s82, 0x3db8aa3b
    s_mov_b32 s59, 0xff
    s_mov_b32 s92, 0x7060500
    s_mov_b32 s93, 0x7060501
    s_mov_b32 s94, 0x7060502
    s_mov_b32 s95, 0x7060503
    s_cmp_lt_u32 s3, 4
    s_cbranch_scc1 L_stream
    s_setprio 3
    s_cmp_lg_u32 s3, 4
    s_cbranch_scc1 L_helper
    s_lshr_b32 s12, s2, 7
    s_lshl_b32 s12, s12, 1
    s_bfe_u32 s13, s2, 0x10003
    s_add_u32 s12, s12, s13
    s_bfe_u32 s13, s2, 0x30004
    s_lshl_b32 s13, s13, 3
    s_and_b32 s8, s2, 7
    s_add_u32 s13, s13, s8
    s_mul_i32 s8, s12, 917504
    s_lshl_b32 s9, s13, 7
    s_add_u32 s8, s8, s9
    v_and_b32 v3, 31, v0
    v_lshrrev_b32 v4, 5, v0
    v_mul_u32_u24 v5, 896, v4
    v_lshl_add_u32 v5, v3, 5, v5
    v_cmp_gt_u32 s[62:63], 28, v3
    v_mov_b32 v6, 0x10000
    s_nop 0
    v_cndmask_b32_e64 v5, v6, v5, s[62:63]
    v_lshrrev_b32 v6, 3, v0
    v_mul_u32_u24 v6, 8192, v6
    v_and_b32 v7, 7, v0
    v_lshl_add_u32 v6, v7, 4, v6
    s_lshr_b32 s11, s2, 1
    s_lshl_b32 s11, s11, 21
    s_waitcnt lgkmcnt(0)
    s_load_dword s5, s[38:39], 0
    s_mov_b32 s40, s38
    s_mov_b32 s41, s39
    s_mov_b32 s42, 1572864
    s_mov_b32 s43, 0x20000
    s_add_u32 s48, s22, s8
    s_addc_u32 s49, s23, 0
    s_sub_u32 s50, 3670016, s8
    s_mov_b32 s51, 0x20000
    s_mov_b32 s44, s16
    s_mov_b32 s45, s17
    s_mov_b32 s46, 1792
    s_mov_b32 s47, 0x20000
    buffer_load_dwordx4 v[8:11], v5, s[44:47], 0 offen
    buffer_load_dwordx4 v[12:15], v5, s[44:47], 0 offen offset:16
    s_mov_b32 s9, 0
    s_mov_b32 m0, 12288
    s_nop 0
    buffer_load_dwordx4 v6, s[48:51], s9 offen sc0 sc1 nt lds
    s_mov_b32 m0, 13312
    s_add_u32 s9, s9, 65536
    buffer_load_dwordx4 v6, s[48:51], s9 offen sc0 sc1 nt lds
    s_mov_b32 m0, 14336
    s_add_u32 s9, s9, 65536
    buffer_load_dwordx4 v6, s[48:51], s9 offen sc0 sc1 nt lds
    s_mov_b32 m0, 15360
    s_add_u32 s9, s9, 65536
    buffer_load_dwordx4 v6, s[48:51], s9 offen sc0 sc1 nt lds
    s_mov_b32 m0, 16384
    s_add_u32 s9, s9, 65536
    buffer_load_dwordx4 v6, s[48:51], s9 offen sc0 sc1 nt lds
    s_mov_b32 m0, 17408
    s_add_u32 s9, s9, 65536
    buffer_load_dwordx4 v6, s[48:51], s9 offen sc0 sc1 nt lds
    s_mov_b32 m0, 18432
    s_add_u32 s9, s9, 65536
    buffer_load_dwordx4 v6, s[48:51], s9 offen sc0 sc1 nt lds
    s_mov_b32 m0, 19456
    s_add_u32 s9, s9, 65536
    buffer_load_dwordx4 v6, s[48:51], s9 offen sc0 sc1 nt lds
    s_mov_b32 m0, 20480
    s_add_u32 s9, s9, 65536
    buffer_load_dwordx4 v6, s[48:51], s9 offen sc0 sc1 nt lds
    s_mov_b32 m0, 21504
    s_add_u32 s9, s9, 65536
    buffer_load_dwordx4 v6, s[48:51], s9 offen sc0 sc1 nt lds
    s_mov_b32 m0, 22528
    s_add_u32 s9, s9, 65536
    buffer_load_dwordx4 v6, s[48:51], s9 offen sc0 sc1 nt lds
    s_mov_b32 m0, 23552
    s_add_u32 s9, s9, 65536
    buffer_load_dwordx4 v6, s[48:51], s9 offen sc0 sc1 nt lds
    s_mov_b32 m0, 24576
    s_add_u32 s9, s9, 65536
    buffer_load_dwordx4 v6, s[48:51], s9 offen sc0 sc1 nt lds
    s_mov_b32 m0, 25600
    s_add_u32 s9, s9, 65536
    buffer_load_dwordx4 v6, s[48:51], s9 offen sc0 sc1 nt lds
    s_barrier
    s_and_b32 s8, s2, 15
    s_cmp_lg_u32 s8, 0
    s_cbranch_scc1 L_nozero
    s_lshr_b32 s8, s2, 4
    s_mul_i32 s8, s8, 4352
    s_add_u32 s8, s8, 327680
    v_mov_b32 v16, 0
    s_mov_b64 exec, 1
    buffer_store_dword v16, v16, s[40:43], s8 offen sc1
    s_mov_b64 exec, -1
L_nozero:
    v_lshlrev_b32 v7, 10, v4
    v_lshl_add_u32 v7, v3, 5, v7
    v_lshrrev_b32 v20, 2, v1
    v_lshl_add_u32 v23, v2, 2, v20
    v_lshl_add_u32 v20, v2, 3, v20
    v_and_b32 v21, 3, v1
    v_lshlrev_b32 v21, 3, v21
    v_lshl_add_u32 v20, v20, 7, v21
    v_lshl_add_u32 v23, v23, 7, v21
    s_mul_i32 s10, s12, 224
    v_and_b32 v21, 1, v1
    v_lshlrev_b32 v21, 10, v21
    v_add_u32 v21, s10, v21
    v_lshl_add_u32 v22, v2, 3, v21
    v_lshl_add_u32 v21, v2, 4, v21
    v_mul_u32_u24 v24, 16384, v2
    v_lshl_add_u32 v24, v1, 4, v24
    s_waitcnt vmcnt(14)
    v_lshlrev_b32 v32, 16, v8
    v_and_b32 v33, 0xffff0000, v8
    v_lshlrev_b32 v34, 16, v9
    v_and_b32 v35, 0xffff0000, v9
    v_lshlrev_b32 v36, 16, v10
    v_and_b32 v37, 0xffff0000, v10
    v_lshlrev_b32 v38, 16, v11
    v_and_b32 v39, 0xffff0000, v11
    v_lshlrev_b32 v40, 16, v12
    v_and_b32 v41, 0xffff0000, v12
    v_lshlrev_b32 v42, 16, v13
    v_and_b32 v43, 0xffff0000, v13
    v_lshlrev_b32 v44, 16, v14
    v_and_b32 v45, 0xffff0000, v14
    v_lshlrev_b32 v46, 16, v15
    v_and_b32 v47, 0xffff0000, v15
    v_add_f32 v48, v32, v33
    v_add_f32 v49, v34, v35
    v_add_f32 v50, v36, v37
    v_add_f32 v51, v38, v39
    v_add_f32 v52, v40, v41
    v_add_f32 v53, v42, v43
    v_add_f32 v54, v44, v45
    v_add_f32 v55, v46, v47
    v_add_f32 v48, v48, v52
    v_add_f32 v49, v49, v53
    v_add_f32 v50, v50, v54
    v_add_f32 v51, v51, v55
    v_add_f32 v48, v48, v50
    v_add_f32 v49, v49, v51
    v_add_f32 v48, v48, v49
    s_nop 1
    v_add_f32_dpp v48, v48, v48 quad_perm:[1,0,3,2] row_mask:0xf bank_mask:0xf
    s_nop 1
    v_add_f32_dpp v48, v48, v48 quad_perm:[2,3,0,1] row_mask:0xf bank_mask:0xf
    s_nop 1
    v_add_f32_dpp v48, v48, v48 row_half_mirror row_mask:0xf bank_mask:0xf
    s_nop 1
    v_add_f32_dpp v48, v48, v48 row_mirror row_mask:0xf bank_mask:0xf
    v_mov_b32 v49, v48
    s_nop 1
    v_permlane16_swap_b32 v48, v49
    v_add_f32 v48, v48, v49
    s_mov_b32 s10, 0x3b124925
    v_mul_f32 v16, s10, v48
    v_sub_f32 v48, v32, v16
    v_sub_f32 v49, v33, v16
    v_sub_f32 v50, v34, v16
    v_sub_f32 v51, v35, v16
    v_sub_f32 v52, v36, v16
    v_sub_f32 v53, v37, v16
    v_sub_f32 v54, v38, v16
    v_sub_f32 v55, v39, v16
    v_sub_f32 v56, v40, v16
    v_sub_f32 v57, v41, v16
    v_sub_f32 v58, v42, v16
    v_sub_f32 v59, v43, v16
    v_sub_f32 v60, v44, v16
    v_sub_f32 v61, v45, v16
    v_sub_f32 v62, v46, v16
    v_sub_f32 v63, v47, v16
    v_mul_f32 v17, v48, v48
    v_mul_f32 v18, v49, v49
    v_fmac_f32 v17, v50, v50
    v_fmac_f32 v18, v51, v51
    v_fmac_f32 v17, v52, v52
    v_fmac_f32 v18, v53, v53
    v_fmac_f32 v17, v54, v54
    v_fmac_f32 v18, v55, v55
    v_fmac_f32 v17, v56, v56
    v_fmac_f32 v18, v57, v57
    v_fmac_f32 v17, v58, v58
    v_fmac_f32 v18, v59, v59
    v_fmac_f32 v17, v60, v60
    v_fmac_f32 v18, v61, v61
    v_fmac_f32 v17, v62, v62
    v_fmac_f32 v18, v63, v63
    v_add_f32 v17, v17, v18
    v_cndmask_b32_e64 v17, 0, v17, s[62:63]
    s_nop 1
    v_add_f32_dpp v17, v17, v17 quad_perm:[1,0,3,2] row_mask:0xf bank_mask:0xf
    s_nop 1
    v_add_f32_dpp v17, v17, v17 quad_perm:[2,3,0,1] row_mask:0xf bank_mask:0xf
    s_nop 1
    v_add_f32_dpp v17, v17, v17 row_half_mirror row_mask:0xf bank_mask:0xf
    s_nop 1
    v_add_f32_dpp v17, v17, v17 row_mirror row_mask:0xf bank_mask:0xf
    v_mov_b32 v18, v17
    s_nop 1
    v_permlane16_swap_b32 v17, v18
    v_add_f32 v17, v17, v18
    v_mul_f32 v17, s10, v17
    v_cvt_pk_bf16_f32 v18, v16, v17
    v_lshlrev_b32 v16, 16, v18
    v_and_b32 v17, 0xffff0000, v18
    v_add_f32 v17, 0x3727c5ac, v17
    v_cvt_pk_bf16_f32 v18, v17, v17
    v_lshlrev_b32 v17, 16, v18
    v_sqrt_f32 v17, v17
    v_sub_f32 v32, v32, v16
    v_sub_f32 v33, v33, v16
    v_sub_f32 v34, v34, v16
    v_sub_f32 v35, v35, v16
    v_sub_f32 v36, v36, v16
    v_sub_f32 v37, v37, v16
    v_sub_f32 v38, v38, v16
    v_sub_f32 v39, v39, v16
    v_sub_f32 v40, v40, v16
    v_sub_f32 v41, v41, v16
    v_sub_f32 v42, v42, v16
    v_sub_f32 v43, v43, v16
    v_sub_f32 v44, v44, v16
    v_sub_f32 v45, v45, v16
    v_sub_f32 v46, v46, v16
    v_sub_f32 v47, v47, v16
    v_cvt_pk_bf16_f32 v18, v17, v17
    v_lshlrev_b32 v17, 16, v18
    v_rcp_f32 v17, v17
    v_cvt_pk_bf16_f32 v8, v32, v33
    v_cvt_pk_bf16_f32 v9, v34, v35
    v_cvt_pk_bf16_f32 v10, v36, v37
    v_cvt_pk_bf16_f32 v11, v38, v39
    v_cvt_pk_bf16_f32 v12, v40, v41
    v_cvt_pk_bf16_f32 v13, v42, v43
    v_cvt_pk_bf16_f32 v14, v44, v45
    v_cvt_pk_bf16_f32 v15, v46, v47
    v_lshlrev_b32 v32, 16, v8
    v_and_b32 v33, 0xffff0000, v8
    v_lshlrev_b32 v34, 16, v9
    v_and_b32 v35, 0xffff0000, v9
    v_lshlrev_b32 v36, 16, v10
    v_and_b32 v37, 0xffff0000, v10
    v_lshlrev_b32 v38, 16, v11
    v_and_b32 v39, 0xffff0000, v11
    v_lshlrev_b32 v40, 16, v12
    v_and_b32 v41, 0xffff0000, v12
    v_lshlrev_b32 v42, 16, v13
    v_and_b32 v43, 0xffff0000, v13
    v_lshlrev_b32 v44, 16, v14
    v_and_b32 v45, 0xffff0000, v14
    v_lshlrev_b32 v46, 16, v15
    v_and_b32 v47, 0xffff0000, v15
    v_mul_f32 v32, v32, v17
    v_mul_f32 v33, v33, v17
    v_mul_f32 v34, v34, v17
    v_mul_f32 v35, v35, v17
    v_mul_f32 v36, v36, v17
    v_mul_f32 v37, v37, v17
    v_mul_f32 v38, v38, v17
    v_mul_f32 v39, v39, v17
    v_mul_f32 v40, v40, v17
    v_mul_f32 v41, v41, v17
    v_mul_f32 v42, v42, v17
    v_mul_f32 v43, v43, v17
    v_mul_f32 v44, v44, v17
    v_mul_f32 v45, v45, v17
    v_mul_f32 v46, v46, v17
    v_mul_f32 v47, v47, v17
    v_cvt_pk_bf16_f32 v8, v32, v33
    v_cvt_pk_bf16_f32 v9, v34, v35
    v_cvt_pk_bf16_f32 v10, v36, v37
    v_cvt_pk_bf16_f32 v11, v38, v39
    v_cvt_pk_bf16_f32 v12, v40, v41
    v_cvt_pk_bf16_f32 v13, v42, v43
    v_cvt_pk_bf16_f32 v14, v44, v45
    v_cvt_pk_bf16_f32 v15, v46, v47
    ds_write_b128 v7, v[8:11] offset:0
    ds_write_b128 v7, v[12:15] offset:16
    s_waitcnt lgkmcnt(0)
    s_mul_i32 s4, s5, 0x9E3779B1
    s_add_u32 s4, s4, 0x7F4A7C15
    s_lshr_b32 s56, s4, 8
    s_lshr_b32 s57, s4, 16
    s_lshr_b32 s58, s4, 24
    v_mov_b32 v223, s4
    s_lshl_b32 s8, s12, 15
    s_lshl_b32 s9, s13, 8
    s_add_u32 s8, s8, s9
    s_add_u32 s8, s8, 65536
    s_waitcnt vmcnt(0)
    ds_read_b128 v[32:35], v21 offset:0
    ds_read_b128 v[36:39], v21 offset:64
    ds_read_b128 v[40:43], v21 offset:128
    ds_read_b64 v[44:45], v22 offset:192
    ds_read_b64_tr_b16 v[48:49], v20 offset:12288
    ds_read_b64_tr_b16 v[50:51], v20 offset:12800
    ds_read_b64_tr_b16 v[52:53], v20 offset:16384
    ds_read_b64_tr_b16 v[54:55], v20 offset:16896
    ds_read_b64_tr_b16 v[56:57], v20 offset:20480
    ds_read_b64_tr_b16 v[58:59], v20 offset:20992
    ds_read_b64_tr_b16 v[60:61], v23 offset:24576
    v_cmp_eq_u32 vcc, 1, v2
    s_waitcnt lgkmcnt(7)
    ds_read_b64_tr_b16 v[62:63], v20 offset:12320
    ds_read_b64_tr_b16 v[64:65], v20 offset:12832
    ds_read_b64_tr_b16 v[66:67], v20 offset:16416
    ds_read_b64_tr_b16 v[68:69], v20 offset:16928
    ds_read_b64_tr_b16 v[70:71], v20 offset:20512
    ds_read_b64_tr_b16 v[72:73], v20 offset:21024
    ds_read_b64_tr_b16 v[74:75], v23 offset:24608
    s_waitcnt lgkmcnt(7)
    v_mfma_f32_16x16x16_bf16 v[120:123], v[44:45], v[60:61], 0
    v_mfma_f32_16x16x32_bf16 v[104:107], v[32:35], v[48:51], 0
    v_mfma_f32_16x16x32_bf16 v[104:107], v[36:39], v[52:55], v[104:107]
    v_mfma_f32_16x16x32_bf16 v[104:107], v[40:43], v[56:59], v[104:107]
    ds_read_b64_tr_b16 v[76:77], v20 offset:12352
    ds_read_b64_tr_b16 v[78:79], v20 offset:12864
    ds_read_b64_tr_b16 v[80:81], v20 offset:16448
    ds_read_b64_tr_b16 v[82:83], v20 offset:16960
    ds_read_b64_tr_b16 v[84:85], v20 offset:20544
    ds_read_b64_tr_b16 v[86:87], v20 offset:21056
    ds_read_b64_tr_b16 v[88:89], v23 offset:24640
    s_waitcnt lgkmcnt(7)
    v_mfma_f32_16x16x16_bf16 v[124:127], v[44:45], v[74:75], 0
    v_mfma_f32_16x16x32_bf16 v[108:111], v[32:35], v[62:65], 0
    v_mfma_f32_16x16x32_bf16 v[108:111], v[36:39], v[66:69], v[108:111]
    v_mfma_f32_16x16x32_bf16 v[108:111], v[40:43], v[70:73], v[108:111]
    ds_read_b64_tr_b16 v[90:91], v20 offset:12384
    ds_read_b64_tr_b16 v[92:93], v20 offset:12896
    ds_read_b64_tr_b16 v[94:95], v20 offset:16480
    ds_read_b64_tr_b16 v[96:97], v20 offset:16992
    ds_read_b64_tr_b16 v[98:99], v20 offset:20576
    ds_read_b64_tr_b16 v[100:101], v20 offset:21088
    ds_read_b64_tr_b16 v[102:103], v23 offset:24672
    s_waitcnt lgkmcnt(7)
    v_mfma_f32_16x16x16_bf16 v[128:131], v[44:45], v[88:89], 0
    v_mfma_f32_16x16x32_bf16 v[112:115], v[32:35], v[76:79], 0
    v_mfma_f32_16x16x32_bf16 v[112:115], v[36:39], v[80:83], v[112:115]
    v_mfma_f32_16x16x32_bf16 v[112:115], v[40:43], v[84:87], v[112:115]
    s_waitcnt lgkmcnt(0)
    v_mfma_f32_16x16x16_bf16 v[132:135], v[44:45], v[102:103], 0
    v_mfma_f32_16x16x32_bf16 v[116:119], v[32:35], v[90:93], 0
    v_mfma_f32_16x16x32_bf16 v[116:119], v[36:39], v[94:97], v[116:119]
    v_mfma_f32_16x16x32_bf16 v[116:119], v[40:43], v[98:101], v[116:119]
    v_cndmask_b32 v32, v120, v121, vcc
    v_cndmask_b32 v28, v104, v105, vcc
    v_add_f32 v28, v28, v32
    v_cndmask_b32 v33, v124, v125, vcc
    v_cndmask_b32 v29, v108, v109, vcc
    v_add_f32 v29, v29, v33
    v_cndmask_b32 v34, v128, v129, vcc
    v_cndmask_b32 v30, v112, v113, vcc
    v_add_f32 v30, v30, v34
    v_cndmask_b32 v35, v132, v133, vcc
    v_cndmask_b32 v31, v116, v117, vcc
    v_add_f32 v31, v31, v35
    v_perm_b32 v28, v28, v223, s92
    v_perm_b32 v29, v29, v223, s93
    v_perm_b32 v30, v30, v223, s94
    v_perm_b32 v31, v31, v223, s95
    s_mov_b32 exec_hi, 0
    buffer_store_dwordx4 v[28:31], v24, s[40:43], s8 offen sc1
    s_mov_b64 exec, -1
    s_lshr_b32 s8, s2, 4
    s_lshl_b32 s8, s8, 11
    s_add_u32 s8, s8, 65536
    s_add_u32 s9, s8, 32768
    s_add_u32 s10, s9, 32768
    s_add_u32 s11, s10, 32768
    v_lshlrev_b32 v3, 4, v0
    v_lshlrev_b32 v4, 7, v2
    v_lshl_add_u32 v4, v1, 1, v4
    s_sleep 48
    s_mov_b32 s60, 0x40000
    buffer_load_dwordx4 v[32:35], v3, s[40:43], s8 offen offset:0 sc1
    buffer_load_dwordx4 v[36:39], v3, s[40:43], s8 offen offset:1024 sc1
    buffer_load_dwordx4 v[40:43], v3, s[40:43], s9 offen offset:0 sc1
    buffer_load_dwordx4 v[44:47], v3, s[40:43], s9 offen offset:1024 sc1
    buffer_load_dwordx4 v[48:51], v3, s[40:43], s10 offen offset:0 sc1
    buffer_load_dwordx4 v[52:55], v3, s[40:43], s10 offen offset:1024 sc1
    buffer_load_dwordx4 v[56:59], v3, s[40:43], s11 offen offset:0 sc1
    buffer_load_dwordx4 v[60:63], v3, s[40:43], s11 offen offset:1024 sc1
    s_barrier
    s_branch L_qpoll_w
L_qpoll:
    buffer_load_dwordx4 v[32:35], v3, s[40:43], s8 offen offset:0 sc1
    buffer_load_dwordx4 v[36:39], v3, s[40:43], s8 offen offset:1024 sc1
    buffer_load_dwordx4 v[40:43], v3, s[40:43], s9 offen offset:0 sc1
    buffer_load_dwordx4 v[44:47], v3, s[40:43], s9 offen offset:1024 sc1
    buffer_load_dwordx4 v[48:51], v3, s[40:43], s10 offen offset:0 sc1
    buffer_load_dwordx4 v[52:55], v3, s[40:43], s10 offen offset:1024 sc1
    buffer_load_dwordx4 v[56:59], v3, s[40:43], s11 offen offset:0 sc1
    buffer_load_dwordx4 v[60:63], v3, s[40:43], s11 offen offset:1024 sc1
L_qpoll_w:
    s_waitcnt vmcnt(0)
    v_xor_b32 v5, s4, v32
    v_xor_b32 v6, s4, v36
    v_bitop3_b32 v5, v5, v40, s4 bitop3:0xf6
    v_bitop3_b32 v6, v6, v44, s4 bitop3:0xf6
    v_bitop3_b32 v5, v5, v48, s4 bitop3:0xf6
    v_bitop3_b32 v6, v6, v52, s4 bitop3:0xf6
    v_bitop3_b32 v5, v5, v56, s4 bitop3:0xf6
    v_bitop3_b32 v6, v6, v60, s4 bitop3:0xf6
    v_bitop3_b32 v5, v5, v33, s56 bitop3:0xf6
    v_bitop3_b32 v6, v6, v37, s56 bitop3:0xf6
    v_bitop3_b32 v5, v5, v41, s56 bitop3:0xf6
    v_bitop3_b32 v6, v6, v45, s56 bitop3:0xf6
    v_bitop3_b32 v5, v5, v49, s56 bitop3:0xf6
    v_bitop3_b32 v6, v6, v53, s56 bitop3:0xf6
    v_bitop3_b32 v5, v5, v57, s56 bitop3:0xf6
    v_bitop3_b32 v6, v6, v61, s56 bitop3:0xf6
    v_bitop3_b32 v5, v5, v34, s57 bitop3:0xf6
    v_bitop3_b32 v6, v6, v38, s57 bitop3:0xf6
    v_bitop3_b32 v5, v5, v42, s57 bitop3:0xf6
    v_bitop3_b32 v6, v6, v46, s57 bitop3:0xf6
    v_bitop3_b32 v5, v5, v50, s57 bitop3:0xf6
    v_bitop3_b32 v6, v6, v54, s57 bitop3:0xf6
    v_bitop3_b32 v5, v5, v58, s57 bitop3:0xf6
    v_bitop3_b32 v6, v6, v62, s57 bitop3:0xf6
    v_bitop3_b32 v5, v5, v35, s58 bitop3:0xf6
    v_bitop3_b32 v6, v6, v39, s58 bitop3:0xf6
    v_bitop3_b32 v5, v5, v43, s58 bitop3:0xf6
    v_bitop3_b32 v6, v6, v47, s58 bitop3:0xf6
    v_bitop3_b32 v5, v5, v51, s58 bitop3:0xf6
    v_bitop3_b32 v6, v6, v55, s58 bitop3:0xf6
    v_bitop3_b32 v5, v5, v59, s58 bitop3:0xf6
    v_bitop3_b32 v6, v6, v63, s58 bitop3:0xf6
    v_bitop3_b32 v5, v5, v6, s59 bitop3:0xa8
    v_cmp_ne_u32 vcc, 0, v5
    s_cbranch_vccz L_qpoll_ok
    s_sleep 2
    s_sub_u32 s60, s60, 1
    s_cmp_lg_u32 s60, 0
    s_cbranch_scc1 L_qpoll
L_qpoll_ok:
    v_add_f32 v32, v32, v40
    v_add_f32 v48, v48, v56
    v_add_f32 v33, v33, v41
    v_add_f32 v49, v49, v57
    v_add_f32 v34, v34, v42
    v_add_f32 v50, v50, v58
    v_add_f32 v35, v35, v43
    v_add_f32 v51, v51, v59
    v_add_f32 v36, v36, v44
    v_add_f32 v52, v52, v60
    v_add_f32 v37, v37, v45
    v_add_f32 v53, v53, v61
    v_add_f32 v38, v38, v46
    v_add_f32 v54, v54, v62
    v_add_f32 v39, v39, v47
    v_add_f32 v55, v55, v63
    v_add_f32 v32, v32, v48
    v_add_f32 v33, v33, v49
    v_add_f32 v34, v34, v50
    v_add_f32 v35, v35, v51
    v_add_f32 v36, v36, v52
    v_add_f32 v37, v37, v53
    v_add_f32 v38, v38, v54
    v_add_f32 v39, v39, v55
    v_cvt_pk_bf16_f32 v8, v32, v33
    v_cvt_pk_bf16_f32 v9, v34, v35
    v_cvt_pk_bf16_f32 v10, v36, v37
    v_cvt_pk_bf16_f32 v11, v38, v39
    ds_write_b16 v4, v8 offset:2048
    ds_write_b16_d16_hi v4, v8 offset:2080
    ds_write_b16 v4, v9 offset:2112
    ds_write_b16_d16_hi v4, v9 offset:2144
    ds_write_b16 v4, v10 offset:2560
    ds_write_b16_d16_hi v4, v10 offset:2592
    ds_write_b16 v4, v11 offset:2624
    ds_write_b16_d16_hi v4, v11 offset:2656
    s_waitcnt lgkmcnt(0)
    s_barrier
    s_lshr_b32 s8, s3, 1
    s_lshl_b32 s8, s8, 3
    s_lshr_b32 s9, s2, 5
    s_add_u32 s8, s8, s9
    s_lshl_b32 s84, s8, 15
    s_and_b32 s9, s7, 7
    s_lshl_b32 s9, s9, 8
    s_add_u32 s84, s84, s9
    s_and_b32 s9, s3, 1
    s_lshl_b32 s10, s9, 7
    s_add_u32 s84, s84, s10
    s_add_u32 s84, s84, 1048576
    s_add_u32 s85, s84, 16384
    v_lshrrev_b32 v221, 3, v0
    v_and_b32 v222, 7, v0
    v_lshlrev_b32 v212, 11, v221
    v_lshl_add_u32 v212, v222, 4, v212
    v_and_b32 v213, 3, v0
    v_lshlrev_b32 v213, 3, v213
    s_lshl_b32 s10, s3, 6
    v_lshl_add_u32 v214, v222, 3, s10
    v_lshl_add_u32 v214, v2, 1, v214
    v_and_b32 v215, 12, v1
    v_add_u32 v215, v215, v2
    v_lshlrev_b32 v215, 9, v215
    v_add_u32 v215, v215, v213
    v_lshrrev_b32 v216, 1, v1
    v_and_b32 v216, 6, v216
    v_and_b32 v217, 1, v2
    v_or_b32 v216, v216, v217
    v_xor_b32 v216, s3, v216
    v_lshl_add_u32 v215, v216, 5, v215
    v_and_b32 v217, 1, v1
    v_lshlrev_b32 v216, 7, v217
    v_lshl_add_u32 v216, v2, 4, v216
    v_mul_u32_u24 v217, 114688, v217
    v_lshl_add_u32 v217, v2, 4, v217
    s_lshl_b32 s10, s6, 3
    s_add_u32 s10, s10, s3
    s_lshl_b32 s10, s10, 12
    s_lshl_b32 s11, s7, 6
    s_add_u32 s10, s10, s11
    s_add_u32 s87, s10, 524288
    s_lshl_b32 s10, s9, 10
    v_lshl_add_u32 v218, v0, 4, s10
    s_lshl_b32 s10, s9, 5
    v_mov_b32 v219, s10
    s_lshl_b32 s88, s2, 11
    s_add_u32 s88, s88, 1048576
    s_branch L_b2
L_stream:
    v_and_b32 v8, 7, v1
    v_lshrrev_b32 v9, 3, v1
    v_lshl_add_u32 v9, v2, 1, v9
    v_lshlrev_b32 v3, 9, v8
    v_lshl_add_u32 v3, v9, 4, v3
    v_add_u32 v4, 4096, v3
    v_lshlrev_b32 v5, 11, v2
    v_lshl_add_u32 v5, v1, 4, v5
    s_lshr_b32 s8, s2, 4
    s_lshl_b32 s8, s8, 24
    s_bfe_u32 s52, s2, 0x30000
    s_lshl_b32 s52, s52, 21
    s_xor_b32 s96, s3, 2
    s_bfe_u32 s9, s2, 0x10003
    s_lshl_b32 s9, s9, 1
    s_and_b32 s10, s3, 1
    s_add_u32 s9, s9, s10
    s_lshl_b32 s9, s9, 13
    s_add_u32 s52, s52, s9
    s_mov_b32 s53, s52
    s_waitcnt lgkmcnt(0)
    s_load_dword s5, s[38:39], 0
    s_mov_b32 s40, s38
    s_mov_b32 s41, s39
    s_mov_b32 s42, 1572864
    s_mov_b32 s43, 0x20000
    s_add_u32 s44, s18, s8
    s_addc_u32 s45, s19, 0
    s_mov_b32 s46, 16777216
    s_mov_b32 s47, 0x20000
    s_add_u32 s48, s20, s8
    s_addc_u32 s49, s21, 0
    s_mov_b32 s50, 16777216
    s_mov_b32 s51, 0x20000
    s_cmp_ge_u32 s96, 2
    s_cbranch_scc1 L_nopre
    buffer_load_dwordx4 v[80:83], v3, s[44:47], s52 offen offset:0 sc0 sc1 nt
    buffer_load_dwordx4 v[84:87], v3, s[44:47], s52 offen offset:128 sc0 sc1 nt
    buffer_load_dwordx4 v[88:91], v3, s[44:47], s52 offen offset:256 sc0 sc1 nt
    buffer_load_dwordx4 v[92:95], v3, s[44:47], s52 offen offset:384 sc0 sc1 nt
L_nopre:
    s_barrier
    s_cmp_ge_u32 s96, 2
    s_cbranch_scc1 L_noissue
    buffer_load_dwordx4 v[96:99], v4, s[44:47], s52 offen offset:0 sc0 sc1 nt
    buffer_load_dwordx4 v[100:103], v4, s[44:47], s52 offen offset:128 sc0 sc1 nt
    buffer_load_dwordx4 v[104:107], v4, s[44:47], s52 offen offset:256 sc0 sc1 nt
    buffer_load_dwordx4 v[108:111], v4, s[44:47], s52 offen offset:384 sc0 sc1 nt
    s_add_u32 s52, s52, 32768
    buffer_load_dwordx4 v[112:115], v3, s[44:47], s52 offen offset:0 sc0 sc1 nt
    buffer_load_dwordx4 v[116:119], v3, s[44:47], s52 offen offset:128 sc0 sc1 nt
    buffer_load_dwordx4 v[120:123], v3, s[44:47], s52 offen offset:256 sc0 sc1 nt
    buffer_load_dwordx4 v[124:127], v3, s[44:47], s52 offen offset:384 sc0 sc1 nt
L_noissue:
    s_mov_b32 s64, 0x30003
    s_mov_b32 s65, s64
    s_mov_b32 s66, 0xc000c
    s_mov_b32 s67, s66
    s_mov_b32 s68, 0x300030
    s_mov_b32 s69, s68
    s_mov_b32 s70, 0xc000c0
    s_mov_b32 s71, s70
    s_mov_b32 s72, 0x3000300
    s_mov_b32 s73, s72
    s_mov_b32 s74, 0xc000c00
    s_mov_b32 s75, s74
    s_mov_b32 s76, 0x30003000
    s_mov_b32 s77, s76
    s_mov_b32 s78, 0xc000c000
    s_mov_b32 s79, s78
    s_mov_b32 s80, 0x05040100
    s_mov_b32 s81, 0x07060302
    v_mov_b32 v6, 0xff800000
    v_mov_b32 v7, 0
    s_lshr_b32 s8, s2, 4
    s_mul_i32 s8, s8, 4352
    s_add_u32 s8, s8, 327680
    s_add_u32 s98, s38, s8
    s_addc_u32 s99, s39, 0
    v_mov_b32 v48, 0
    v_mov_b32 v49, 0
    v_mov_b32 v50, 0
    v_mov_b32 v51, 0
    v_mov_b32 v52, 0
    v_mov_b32 v53, 0
    v_mov_b32 v54, 0
    v_mov_b32 v55, 0
    v_and_b32 v8, 1, v1
    v_bfe_u32 v9, v1, 1, 1
    v_lshlrev_b32 v77, 9, v8
    v_lshl_add_u32 v77, v2, 5, v77
    v_lshl_add_u32 v77, v9, 4, v77
    s_lshl_b32 s8, s10, 12
    s_add_u32 s8, s8, 65536
    v_lshl_add_u32 v76, v2, 4, s8
    v_lshl_add_u32 v76, v8, 3, v76
    s_lshl_b32 s8, s10, 8
    s_add_u32 s8, s8, 73728
    v_lshl_add_u32 v78, v0, 2, s8
    s_lshr_b32 s8, s3, 1
    s_lshl_b32 s8, s8, 3
    s_lshr_b32 s9, s2, 5
    s_add_u32 s8, s8, s9
    s_lshl_b32 s84, s8, 15
    s_and_b32 s9, s7, 7
    s_lshl_b32 s9, s9, 8
    s_add_u32 s84, s84, s9
    s_and_b32 s9, s3, 1
    s_lshl_b32 s10, s9, 7
    s_add_u32 s84, s84, s10
    s_add_u32 s84, s84, 1048576
    s_add_u32 s85, s84, 16384
    v_lshrrev_b32 v221, 3, v0
    v_and_b32 v222, 7, v0
    v_lshlrev_b32 v212, 11, v221
    v_lshl_add_u32 v212, v222, 4, v212
    v_and_b32 v213, 3, v0
    v_lshlrev_b32 v213, 3, v213
    s_lshl_b32 s10, s3, 6
    v_lshl_add_u32 v214, v222, 3, s10
    v_lshl_add_u32 v214, v2, 1, v214
    v_and_b32 v215, 12, v1
    v_add_u32 v215, v215, v2
    v_lshlrev_b32 v215, 9, v215
    v_add_u32 v215, v215, v213
    v_lshrrev_b32 v216, 1, v1
    v_and_b32 v216, 6, v216
    v_and_b32 v217, 1, v2
    v_or_b32 v216, v216, v217
    v_xor_b32 v216, s3, v216
    v_lshl_add_u32 v215, v216, 5, v215
    v_and_b32 v217, 1, v1
    v_lshlrev_b32 v216, 7, v217
    v_lshl_add_u32 v216, v2, 4, v216
    v_mul_u32_u24 v217, 114688, v217
    v_lshl_add_u32 v217, v2, 4, v217
    s_lshl_b32 s10, s6, 3
    s_add_u32 s10, s10, s3
    s_lshl_b32 s10, s10, 12
    s_lshl_b32 s11, s7, 6
    s_add_u32 s10, s10, s11
    s_add_u32 s87, s10, 524288
    s_lshl_b32 s10, s9, 10
    v_lshl_add_u32 v218, v0, 4, s10
    s_lshl_b32 s10, s9, 5
    v_mov_b32 v219, s10
    s_lshl_b32 s88, s2, 11
    s_add_u32 s88, s88, 1048576
    s_cmp_lt_u32 s96, 2
    s_cbranch_scc1 L_main
    v_mov_b32 v8, 0
    ds_write_b32 v78, v8 offset:512
    s_waitcnt lgkmcnt(0)
    s_mul_i32 s4, s5, 0x9E3779B1
    s_add_u32 s4, s4, 0x7F4A7C15
    s_lshr_b32 s56, s4, 8
    s_lshr_b32 s57, s4, 16
    s_lshr_b32 s58, s4, 24
    v_mov_b32 v223, s4
    s_add_u32 s52, s52, 1835008
    s_barrier
    buffer_load_dwordx4 v[80:83], v3, s[44:47], s52 offen offset:0 sc0 sc1 nt
    buffer_load_dwordx4 v[84:87], v3, s[44:47], s52 offen offset:128 sc0 sc1 nt
    buffer_load_dwordx4 v[88:91], v3, s[44:47], s52 offen offset:256 sc0 sc1 nt
    buffer_load_dwordx4 v[92:95], v3, s[44:47], s52 offen offset:384 sc0 sc1 nt
    buffer_load_dwordx4 v[96:99], v4, s[44:47], s52 offen offset:0 sc0 sc1 nt
    buffer_load_dwordx4 v[100:103], v4, s[44:47], s52 offen offset:128 sc0 sc1 nt
    buffer_load_dwordx4 v[104:107], v4, s[44:47], s52 offen offset:256 sc0 sc1 nt
    buffer_load_dwordx4 v[108:111], v4, s[44:47], s52 offen offset:384 sc0 sc1 nt
    s_add_u32 s52, s52, 32768
    buffer_load_dwordx4 v[112:115], v3, s[44:47], s52 offen offset:0 sc0 sc1 nt
    buffer_load_dwordx4 v[116:119], v3, s[44:47], s52 offen offset:128 sc0 sc1 nt
    buffer_load_dwordx4 v[120:123], v3, s[44:47], s52 offen offset:256 sc0 sc1 nt
    buffer_load_dwordx4 v[124:127], v3, s[44:47], s52 offen offset:384 sc0 sc1 nt
    s_waitcnt vmcnt(8)
    buffer_load_dwordx4 v[128:131], v4, s[44:47], s52 offen offset:0 sc0 sc1 nt
    buffer_load_dwordx4 v[132:135], v4, s[44:47], s52 offen offset:128 sc0 sc1 nt
    buffer_load_dwordx4 v[136:139], v4, s[44:47], s52 offen offset:256 sc0 sc1 nt
    buffer_load_dwordx4 v[140:143], v4, s[44:47], s52 offen offset:384 sc0 sc1 nt
    s_add_u32 s52, s52, 32768
    s_waitcnt vmcnt(8)
    buffer_load_dwordx4 v[144:147], v3, s[44:47], s52 offen offset:0 sc0 sc1 nt
    buffer_load_dwordx4 v[148:151], v3, s[44:47], s52 offen offset:128 sc0 sc1 nt
    buffer_load_dwordx4 v[152:155], v3, s[44:47], s52 offen offset:256 sc0 sc1 nt
    buffer_load_dwordx4 v[156:159], v3, s[44:47], s52 offen offset:384 sc0 sc1 nt
    s_waitcnt vmcnt(8)
    buffer_load_dwordx4 v[160:163], v4, s[44:47], s52 offen offset:0 sc0 sc1 nt
    buffer_load_dwordx4 v[164:167], v4, s[44:47], s52 offen offset:128 sc0 sc1 nt
    buffer_load_dwordx4 v[168:171], v4, s[44:47], s52 offen offset:256 sc0 sc1 nt
    buffer_load_dwordx4 v[172:175], v4, s[44:47], s52 offen offset:384 sc0 sc1 nt
    s_add_u32 s52, s52, 32768
    s_waitcnt vmcnt(8)
    buffer_load_dwordx4 v[176:179], v3, s[44:47], s52 offen offset:0 sc0 sc1 nt
    buffer_load_dwordx4 v[180:183], v3, s[44:47], s52 offen offset:128 sc0 sc1 nt
    buffer_load_dwordx4 v[184:187], v3, s[44:47], s52 offen offset:256 sc0 sc1 nt
    buffer_load_dwordx4 v[188:191], v3, s[44:47], s52 offen offset:384 sc0 sc1 nt
    s_waitcnt vmcnt(8)
    buffer_load_dwordx4 v[192:195], v4, s[44:47], s52 offen offset:0 sc0 sc1 nt
    buffer_load_dwordx4 v[196:199], v4, s[44:47], s52 offen offset:128 sc0 sc1 nt
    buffer_load_dwordx4 v[200:203], v4, s[44:47], s52 offen offset:256 sc0 sc1 nt
    buffer_load_dwordx4 v[204:207], v4, s[44:47], s52 offen offset:384 sc0 sc1 nt
    s_add_u32 s52, s52, 32768
    s_barrier
    ds_read_b128 v[56:59], v77 offset:2048
    ds_read_b128 v[60:63], v77 offset:2176
    ds_read_b128 v[64:67], v77 offset:2304
    ds_read_b128 v[68:71], v77 offset:2432
    s_waitcnt vmcnt(8) lgkmcnt(0)
    v_mfma_f32_16x16x32_bf16 v[8:11], v[80:83], v[56:59], 0
    v_mfma_f32_16x16x32_bf16 v[8:11], v[84:87], v[60:63], v[8:11]
    v_mfma_f32_16x16x32_bf16 v[8:11], v[88:91], v[64:67], v[8:11]
    v_mfma_f32_16x16x32_bf16 v[8:11], v[92:95], v[68:71], v[8:11]
    s_waitcnt vmcnt(8) lgkmcnt(0)
    v_mfma_f32_16x16x32_bf16 v[12:15], v[96:99], v[56:59], 0
    v_mfma_f32_16x16x32_bf16 v[12:15], v[100:103], v[60:63], v[12:15]
    v_mfma_f32_16x16x32_bf16 v[12:15], v[104:107], v[64:67], v[12:15]
    v_mfma_f32_16x16x32_bf16 v[12:15], v[108:111], v[68:71], v[12:15]
    s_nop 7
    v_permlane32_swap_b32 v8, v12
    v_permlane32_swap_b32 v9, v13
    v_permlane32_swap_b32 v10, v14
    v_permlane32_swap_b32 v11, v15
    v_mov_b32_dpp v16, v12 quad_perm:[2,3,2,3] row_mask:0xf bank_mask:0xf
    v_mov_b32_dpp v17, v13 quad_perm:[2,3,2,3] row_mask:0xf bank_mask:0xf
    v_mov_b32_dpp v18, v14 quad_perm:[2,3,2,3] row_mask:0xf bank_mask:0xf
    v_mov_b32_dpp v19, v15 quad_perm:[2,3,2,3] row_mask:0xf bank_mask:0xf
    v_add_f32_dpp v8, v8, v16 quad_perm:[0,1,0,1] row_mask:0xf bank_mask:0xf
    v_add_f32_dpp v9, v9, v17 quad_perm:[0,1,0,1] row_mask:0xf bank_mask:0xf
    v_add_f32_dpp v10, v10, v18 quad_perm:[0,1,0,1] row_mask:0xf bank_mask:0xf
    v_add_f32_dpp v11, v11, v19 quad_perm:[0,1,0,1] row_mask:0xf bank_mask:0xf
    v_cvt_pk_bf16_f32 v16, v8, v9
    v_cvt_pk_bf16_f32 v17, v10, v11
    s_mov_b64 exec, s[64:65]
    ds_write_b64 v76, v[16:17] offset:3584
    s_mov_b64 exec, -1
    v_max3_f32 v6, v6, v8, v9
    v_max3_f32 v6, v6, v10, v11
    s_waitcnt vmcnt(8) lgkmcnt(0)
    v_mfma_f32_16x16x32_bf16 v[8:11], v[112:115], v[56:59], 0
    v_mfma_f32_16x16x32_bf16 v[8:11], v[116:119], v[60:63], v[8:11]
    v_mfma_f32_16x16x32_bf16 v[8:11], v[120:123], v[64:67], v[8:11]
    v_mfma_f32_16x16x32_bf16 v[8:11], v[124:127], v[68:71], v[8:11]
    s_waitcnt vmcnt(8) lgkmcnt(0)
    v_mfma_f32_16x16x32_bf16 v[12:15], v[128:131], v[56:59], 0
    v_mfma_f32_16x16x32_bf16 v[12:15], v[132:135], v[60:63], v[12:15]
    v_mfma_f32_16x16x32_bf16 v[12:15], v[136:139], v[64:67], v[12:15]
    v_mfma_f32_16x16x32_bf16 v[12:15], v[140:143], v[68:71], v[12:15]
    s_nop 7
    v_permlane32_swap_b32 v8, v12
    v_permlane32_swap_b32 v9, v13
    v_permlane32_swap_b32 v10, v14
    v_permlane32_swap_b32 v11, v15
    v_mov_b32_dpp v16, v12 quad_perm:[2,3,2,3] row_mask:0xf bank_mask:0xf
    v_mov_b32_dpp v17, v13 quad_perm:[2,3,2,3] row_mask:0xf bank_mask:0xf
    v_mov_b32_dpp v18, v14 quad_perm:[2,3,2,3] row_mask:0xf bank_mask:0xf
    v_mov_b32_dpp v19, v15 quad_perm:[2,3,2,3] row_mask:0xf bank_mask:0xf
    v_add_f32_dpp v8, v8, v16 quad_perm:[0,1,0,1] row_mask:0xf bank_mask:0xf
    v_add_f32_dpp v9, v9, v17 quad_perm:[0,1,0,1] row_mask:0xf bank_mask:0xf
    v_add_f32_dpp v10, v10, v18 quad_perm:[0,1,0,1] row_mask:0xf bank_mask:0xf
    v_add_f32_dpp v11, v11, v19 quad_perm:[0,1,0,1] row_mask:0xf bank_mask:0xf
    v_cvt_pk_bf16_f32 v16, v8, v9
    v_cvt_pk_bf16_f32 v17, v10, v11
    s_mov_b64 exec, s[64:65]
    ds_write_b64 v76, v[16:17] offset:3648
    s_mov_b64 exec, -1
    v_max3_f32 v6, v6, v8, v9
    v_max3_f32 v6, v6, v10, v11
    s_waitcnt vmcnt(8) lgkmcnt(0)
    v_mfma_f32_16x16x32_bf16 v[8:11], v[144:147], v[56:59], 0
    v_mfma_f32_16x16x32_bf16 v[8:11], v[148:151], v[60:63], v[8:11]
    v_mfma_f32_16x16x32_bf16 v[8:11], v[152:155], v[64:67], v[8:11]
    v_mfma_f32_16x16x32_bf16 v[8:11], v[156:159], v[68:71], v[8:11]
    s_waitcnt vmcnt(8) lgkmcnt(0)
    v_mfma_f32_16x16x32_bf16 v[12:15], v[160:163], v[56:59], 0
    v_mfma_f32_16x16x32_bf16 v[12:15], v[164:167], v[60:63], v[12:15]
    v_mfma_f32_16x16x32_bf16 v[12:15], v[168:171], v[64:67], v[12:15]
    v_mfma_f32_16x16x32_bf16 v[12:15], v[172:175], v[68:71], v[12:15]
    s_nop 7
    v_permlane32_swap_b32 v8, v12
    v_permlane32_swap_b32 v9, v13
    v_permlane32_swap_b32 v10, v14
    v_permlane32_swap_b32 v11, v15
    v_mov_b32_dpp v16, v12 quad_perm:[2,3,2,3] row_mask:0xf bank_mask:0xf
    v_mov_b32_dpp v17, v13 quad_perm:[2,3,2,3] row_mask:0xf bank_mask:0xf
    v_mov_b32_dpp v18, v14 quad_perm:[2,3,2,3] row_mask:0xf bank_mask:0xf
    v_mov_b32_dpp v19, v15 quad_perm:[2,3,2,3] row_mask:0xf bank_mask:0xf
    v_add_f32_dpp v8, v8, v16 quad_perm:[0,1,0,1] row_mask:0xf bank_mask:0xf
    v_add_f32_dpp v9, v9, v17 quad_perm:[0,1,0,1] row_mask:0xf bank_mask:0xf
    v_add_f32_dpp v10, v10, v18 quad_perm:[0,1,0,1] row_mask:0xf bank_mask:0xf
    v_add_f32_dpp v11, v11, v19 quad_perm:[0,1,0,1] row_mask:0xf bank_mask:0xf
    v_cvt_pk_bf16_f32 v16, v8, v9
    v_cvt_pk_bf16_f32 v17, v10, v11
    s_mov_b64 exec, s[64:65]
    ds_write_b64 v76, v[16:17] offset:3712
    s_mov_b64 exec, -1
    v_max3_f32 v6, v6, v8, v9
    v_max3_f32 v6, v6, v10, v11
    s_waitcnt vmcnt(4) lgkmcnt(0)
    v_mfma_f32_16x16x32_bf16 v[8:11], v[176:179], v[56:59], 0
    v_mfma_f32_16x16x32_bf16 v[8:11], v[180:183], v[60:63], v[8:11]
    v_mfma_f32_16x16x32_bf16 v[8:11], v[184:187], v[64:67], v[8:11]
    v_mfma_f32_16x16x32_bf16 v[8:11], v[188:191], v[68:71], v[8:11]
    s_waitcnt vmcnt(0) lgkmcnt(0)
    v_mfma_f32_16x16x32_bf16 v[12:15], v[192:195], v[56:59], 0
    v_mfma_f32_16x16x32_bf16 v[12:15], v[196:199], v[60:63], v[12:15]
    v_mfma_f32_16x16x32_bf16 v[12:15], v[200:203], v[64:67], v[12:15]
    v_mfma_f32_16x16x32_bf16 v[12:15], v[204:207], v[68:71], v[12:15]
    s_nop 7
    v_permlane32_swap_b32 v8, v12
    v_permlane32_swap_b32 v9, v13
    v_permlane32_swap_b32 v10, v14
    v_permlane32_swap_b32 v11, v15
    v_mov_b32_dpp v16, v12 quad_perm:[2,3,2,3] row_mask:0xf bank_mask:0xf
    v_mov_b32_dpp v17, v13 quad_perm:[2,3,2,3] row_mask:0xf bank_mask:0xf
    v_mov_b32_dpp v18, v14 quad_perm:[2,3,2,3] row_mask:0xf bank_mask:0xf
    v_mov_b32_dpp v19, v15 quad_perm:[2,3,2,3] row_mask:0xf bank_mask:0xf
    v_add_f32_dpp v8, v8, v16 quad_perm:[0,1,0,1] row_mask:0xf bank_mask:0xf
    v_add_f32_dpp v9, v9, v17 quad_perm:[0,1,0,1] row_mask:0xf bank_mask:0xf
    v_add_f32_dpp v10, v10, v18 quad_perm:[0,1,0,1] row_mask:0xf bank_mask:0xf
    v_add_f32_dpp v11, v11, v19 quad_perm:[0,1,0,1] row_mask:0xf bank_mask:0xf
    v_cvt_pk_bf16_f32 v16, v8, v9
    v_cvt_pk_bf16_f32 v17, v10, v11
    s_mov_b64 exec, s[64:65]
    ds_write_b64 v76, v[16:17] offset:3776
    s_mov_b64 exec, -1
    v_max3_f32 v6, v6, v8, v9
    v_max3_f32 v6, v6, v10, v11
    ds_write_b32 v78, v6
    v_mov_b32 v8, 1
    s_waitcnt lgkmcnt(0)
    ds_write_b32 v78, v8 offset:512
    s_waitcnt lgkmcnt(0)
    s_branch L_b2
L_main:
    s_waitcnt vmcnt(8)
    buffer_load_dwordx4 v[128:131], v4, s[44:47], s52 offen offset:0 sc0 sc1 nt
    buffer_load_dwordx4 v[132:135], v4, s[44:47], s52 offen offset:128 sc0 sc1 nt
    buffer_load_dwordx4 v[136:139], v4, s[44:47], s52 offen offset:256 sc0 sc1 nt
    buffer_load_dwordx4 v[140:143], v4, s[44:47], s52 offen offset:384 sc0 sc1 nt
    s_add_u32 s52, s52, 32768
    s_waitcnt vmcnt(8)
    buffer_load_dwordx4 v[144:147], v3, s[44:47], s52 offen offset:0 sc0 sc1 nt
    buffer_load_dwordx4 v[148:151], v3, s[44:47], s52 offen offset:128 sc0 sc1 nt
    buffer_load_dwordx4 v[152:155], v3, s[44:47], s52 offen offset:256 sc0 sc1 nt
    buffer_load_dwordx4 v[156:159], v3, s[44:47], s52 offen offset:384 sc0 sc1 nt
    s_waitcnt vmcnt(8)
    buffer_load_dwordx4 v[160:163], v4, s[44:47], s52 offen offset:0 sc0 sc1 nt
    buffer_load_dwordx4 v[164:167], v4, s[44:47], s52 offen offset:128 sc0 sc1 nt
    buffer_load_dwordx4 v[168:171], v4, s[44:47], s52 offen offset:256 sc0 sc1 nt
    buffer_load_dwordx4 v[172:175], v4, s[44:47], s52 offen offset:384 sc0 sc1 nt
    s_add_u32 s52, s52, 32768
    s_waitcnt vmcnt(8)
    buffer_load_dwordx4 v[176:179], v3, s[44:47], s52 offen offset:0 sc0 sc1 nt
    buffer_load_dwordx4 v[180:183], v3, s[44:47], s52 offen offset:128 sc0 sc1 nt
    buffer_load_dwordx4 v[184:187], v3, s[44:47], s52 offen offset:256 sc0 sc1 nt
    buffer_load_dwordx4 v[188:191], v3, s[44:47], s52 offen offset:384 sc0 sc1 nt
    s_waitcnt vmcnt(8)
    buffer_load_dwordx4 v[192:195], v4, s[44:47], s52 offen offset:0 sc0 sc1 nt
    buffer_load_dwordx4 v[196:199], v4, s[44:47], s52 offen offset:128 sc0 sc1 nt
    buffer_load_dwordx4 v[200:203], v4, s[44:47], s52 offen offset:256 sc0 sc1 nt
    buffer_load_dwordx4 v[204:207], v4, s[44:47], s52 offen offset:384 sc0 sc1 nt
    s_add_u32 s52, s52, 32768
    s_waitcnt lgkmcnt(0)
    s_mul_i32 s4, s5, 0x9E3779B1
    s_add_u32 s4, s4, 0x7F4A7C15
    s_lshr_b32 s56, s4, 8
    s_lshr_b32 s57, s4, 16
    s_lshr_b32 s58, s4, 24
    v_mov_b32 v223, s4
    s_barrier
    s_barrier
    ds_read_b128 v[56:59], v77 offset:2048
    ds_read_b128 v[60:63], v77 offset:2176
    ds_read_b128 v[64:67], v77 offset:2304
    ds_read_b128 v[68:71], v77 offset:2432
    s_waitcnt lgkmcnt(0)
    v_mfma_f32_16x16x32_bf16 v[8:11], v[80:83], v[56:59], 0
    v_mfma_f32_16x16x32_bf16 v[8:11], v[84:87], v[60:63], v[8:11]
    v_mfma_f32_16x16x32_bf16 v[8:11], v[88:91], v[64:67], v[8:11]
    v_mfma_f32_16x16x32_bf16 v[8:11], v[92:95], v[68:71], v[8:11]
    s_waitcnt vmcnt(8)
    buffer_load_dwordx4 v[80:83], v3, s[44:47], s52 offen offset:0 sc0 sc1 nt
    buffer_load_dwordx4 v[84:87], v3, s[44:47], s52 offen offset:128 sc0 sc1 nt
    buffer_load_dwordx4 v[88:91], v3, s[44:47], s52 offen offset:256 sc0 sc1 nt
    buffer_load_dwordx4 v[92:95], v3, s[44:47], s52 offen offset:384 sc0 sc1 nt
    v_mfma_f32_16x16x32_bf16 v[12:15], v[96:99], v[56:59], 0
    v_mfma_f32_16x16x32_bf16 v[12:15], v[100:103], v[60:63], v[12:15]
    v_mfma_f32_16x16x32_bf16 v[12:15], v[104:107], v[64:67], v[12:15]
    v_mfma_f32_16x16x32_bf16 v[12:15], v[108:111], v[68:71], v[12:15]
    s_nop 7
    v_permlane32_swap_b32 v8, v12
    v_permlane32_swap_b32 v9, v13
    v_permlane32_swap_b32 v10, v14
    v_permlane32_swap_b32 v11, v15
    v_mov_b32_dpp v16, v12 quad_perm:[2,3,2,3] row_mask:0xf bank_mask:0xf
    v_mov_b32_dpp v17, v13 quad_perm:[2,3,2,3] row_mask:0xf bank_mask:0xf
    v_mov_b32_dpp v18, v14 quad_perm:[2,3,2,3] row_mask:0xf bank_mask:0xf
    v_mov_b32_dpp v19, v15 quad_perm:[2,3,2,3] row_mask:0xf bank_mask:0xf
    v_add_f32_dpp v8, v8, v16 quad_perm:[0,1,0,1] row_mask:0xf bank_mask:0xf
    v_add_f32_dpp v9, v9, v17 quad_perm:[0,1,0,1] row_mask:0xf bank_mask:0xf
    v_add_f32_dpp v10, v10, v18 quad_perm:[0,1,0,1] row_mask:0xf bank_mask:0xf
    v_add_f32_dpp v11, v11, v19 quad_perm:[0,1,0,1] row_mask:0xf bank_mask:0xf
    v_cvt_pk_bf16_f32 v16, v8, v9
    v_cvt_pk_bf16_f32 v17, v10, v11
    s_mov_b64 exec, s[64:65]
    ds_write_b64 v76, v[16:17] offset:0
    s_mov_b64 exec, -1
    v_max3_f32 v6, v6, v8, v9
    v_max3_f32 v6, v6, v10, v11
    s_waitcnt vmcnt(8)
    buffer_load_dwordx4 v[96:99], v4, s[44:47], s52 offen offset:0 sc0 sc1 nt
    buffer_load_dwordx4 v[100:103], v4, s[44:47], s52 offen offset:128 sc0 sc1 nt
    buffer_load_dwordx4 v[104:107], v4, s[44:47], s52 offen offset:256 sc0 sc1 nt
    buffer_load_dwordx4 v[108:111], v4, s[44:47], s52 offen offset:384 sc0 sc1 nt
    s_add_u32 s52, s52, 32768
    v_mfma_f32_16x16x32_bf16 v[8:11], v[112:115], v[56:59], 0
    v_mfma_f32_16x16x32_bf16 v[8:11], v[116:119], v[60:63], v[8:11]
    v_mfma_f32_16x16x32_bf16 v[8:11], v[120:123], v[64:67], v[8:11]
    v_mfma_f32_16x16x32_bf16 v[8:11], v[124:127], v[68:71], v[8:11]
    s_waitcnt vmcnt(8)
    buffer_load_dwordx4 v[112:115], v3, s[44:47], s52 offen offset:0 sc0 sc1 nt
    buffer_load_dwordx4 v[116:119], v3, s[44:47], s52 offen offset:128 sc0 sc1 nt
    buffer_load_dwordx4 v[120:123], v3, s[44:47], s52 offen offset:256 sc0 sc1 nt
    buffer_load_dwordx4 v[124:127], v3, s[44:47], s52 offen offset:384 sc0 sc1 nt
    v_mfma_f32_16x16x32_bf16 v[12:15], v[128:131], v[56:59], 0
    v_mfma_f32_16x16x32_bf16 v[12:15], v[132:135], v[60:63], v[12:15]
    v_mfma_f32_16x16x32_bf16 v[12:15], v[136:139], v[64:67], v[12:15]
    v_mfma_f32_16x16x32_bf16 v[12:15], v[140:143], v[68:71], v[12:15]
    s_nop 7
    v_permlane32_swap_b32 v8, v12
    v_permlane32_swap_b32 v9, v13
    v_permlane32_swap_b32 v10, v14
    v_permlane32_swap_b32 v11, v15
    v_mov_b32_dpp v16, v12 quad_perm:[2,3,2,3] row_mask:0xf bank_mask:0xf
    v_mov_b32_dpp v17, v13 quad_perm:[2,3,2,3] row_mask:0xf bank_mask:0xf
    v_mov_b32_dpp v18, v14 quad_perm:[2,3,2,3] row_mask:0xf bank_mask:0xf
    v_mov_b32_dpp v19, v15 quad_perm:[2,3,2,3] row_mask:0xf bank_mask:0xf
    v_add_f32_dpp v8, v8, v16 quad_perm:[0,1,0,1] row_mask:0xf bank_mask:0xf
    v_add_f32_dpp v9, v9, v17 quad_perm:[0,1,0,1] row_mask:0xf bank_mask:0xf
    v_add_f32_dpp v10, v10, v18 quad_perm:[0,1,0,1] row_mask:0xf bank_mask:0xf
    v_add_f32_dpp v11, v11, v19 quad_perm:[0,1,0,1] row_mask:0xf bank_mask:0xf
    v_cvt_pk_bf16_f32 v16, v8, v9
    v_cvt_pk_bf16_f32 v17, v10, v11
    s_mov_b64 exec, s[64:65]
    ds_write_b64 v76, v[16:17] offset:64
    s_mov_b64 exec, -1
    v_max3_f32 v6, v6, v8, v9
    v_max3_f32 v6, v6, v10, v11
    v_mfma_f32_16x16x32_bf16 v[8:11], v[144:147], v[56:59], 0
    v_mfma_f32_16x16x32_bf16 v[8:11], v[148:151], v[60:63], v[8:11]
    v_mfma_f32_16x16x32_bf16 v[8:11], v[152:155], v[64:67], v[8:11]
    v_mfma_f32_16x16x32_bf16 v[8:11], v[156:159], v[68:71], v[8:11]
    v_mfma_f32_16x16x32_bf16 v[12:15], v[160:163], v[56:59], 0
    v_mfma_f32_16x16x32_bf16 v[12:15], v[164:167], v[60:63], v[12:15]
    v_mfma_f32_16x16x32_bf16 v[12:15], v[168:171], v[64:67], v[12:15]
    v_mfma_f32_16x16x32_bf16 v[12:15], v[172:175], v[68:71], v[12:15]
    s_nop 7
    v_permlane32_swap_b32 v8, v12
    v_permlane32_swap_b32 v9, v13
    v_permlane32_swap_b32 v10, v14
    v_permlane32_swap_b32 v11, v15
    v_mov_b32_dpp v16, v12 quad_perm:[2,3,2,3] row_mask:0xf bank_mask:0xf
    v_mov_b32_dpp v17, v13 quad_perm:[2,3,2,3] row_mask:0xf bank_mask:0xf
    v_mov_b32_dpp v18, v14 quad_perm:[2,3,2,3] row_mask:0xf bank_mask:0xf
    v_mov_b32_dpp v19, v15 quad_perm:[2,3,2,3] row_mask:0xf bank_mask:0xf
    v_add_f32_dpp v8, v8, v16 quad_perm:[0,1,0,1] row_mask:0xf bank_mask:0xf
    v_add_f32_dpp v9, v9, v17 quad_perm:[0,1,0,1] row_mask:0xf bank_mask:0xf
    v_add_f32_dpp v10, v10, v18 quad_perm:[0,1,0,1] row_mask:0xf bank_mask:0xf
    v_add_f32_dpp v11, v11, v19 quad_perm:[0,1,0,1] row_mask:0xf bank_mask:0xf
    v_cvt_pk_bf16_f32 v16, v8, v9
    v_cvt_pk_bf16_f32 v17, v10, v11
    s_mov_b64 exec, s[64:65]
    ds_write_b64 v76, v[16:17] offset:128
    s_mov_b64 exec, -1
    v_max3_f32 v6, v6, v8, v9
    v_max3_f32 v6, v6, v10, v11
    v_mfma_f32_16x16x32_bf16 v[8:11], v[176:179], v[56:59], 0
    v_mfma_f32_16x16x32_bf16 v[8:11], v[180:183], v[60:63], v[8:11]
    v_mfma_f32_16x16x32_bf16 v[8:11], v[184:187], v[64:67], v[8:11]
    v_mfma_f32_16x16x32_bf16 v[8:11], v[188:191], v[68:71], v[8:11]
    v_mfma_f32_16x16x32_bf16 v[12:15], v[192:195], v[56:59], 0
    v_mfma_f32_16x16x32_bf16 v[12:15], v[196:199], v[60:63], v[12:15]
    v_mfma_f32_16x16x32_bf16 v[12:15], v[200:203], v[64:67], v[12:15]
    v_mfma_f32_16x16x32_bf16 v[12:15], v[204:207], v[68:71], v[12:15]
    s_nop 7
    v_permlane32_swap_b32 v8, v12
    v_permlane32_swap_b32 v9, v13
    v_permlane32_swap_b32 v10, v14
    v_permlane32_swap_b32 v11, v15
    v_mov_b32_dpp v16, v12 quad_perm:[2,3,2,3] row_mask:0xf bank_mask:0xf
    v_mov_b32_dpp v17, v13 quad_perm:[2,3,2,3] row_mask:0xf bank_mask:0xf
    v_mov_b32_dpp v18, v14 quad_perm:[2,3,2,3] row_mask:0xf bank_mask:0xf
    v_mov_b32_dpp v19, v15 quad_perm:[2,3,2,3] row_mask:0xf bank_mask:0xf
    v_add_f32_dpp v8, v8, v16 quad_perm:[0,1,0,1] row_mask:0xf bank_mask:0xf
    v_add_f32_dpp v9, v9, v17 quad_perm:[0,1,0,1] row_mask:0xf bank_mask:0xf
    v_add_f32_dpp v10, v10, v18 quad_perm:[0,1,0,1] row_mask:0xf bank_mask:0xf
    v_add_f32_dpp v11, v11, v19 quad_perm:[0,1,0,1] row_mask:0xf bank_mask:0xf
    v_cvt_pk_bf16_f32 v16, v8, v9
    v_cvt_pk_bf16_f32 v17, v10, v11
    s_mov_b64 exec, s[64:65]
    ds_write_b64 v76, v[16:17] offset:192
    s_mov_b64 exec, -1
    v_max3_f32 v6, v6, v8, v9
    v_max3_f32 v6, v6, v10, v11
    v_add_u32 v76, 256, v76
    s_lshr_b32 s8, s2, 4
    s_add_u32 s8, s8, s2
    s_and_b32 s8, s8, 3
    s_and_b32 s9, s7, 7
    s_cmp_eq_u32 s9, 7
    s_cselect_b32 s8, 0, s8
    s_cmp_eq_u32 s8, 1
    s_cselect_b64 vcc, -1, 0
    s_mov_b32 s54, 25
L_kloop:
    s_cbranch_vccnz L_bo0
    s_waitcnt vmcnt(8)
L_bo0:
    buffer_load_dwordx4 v[128:131], v4, s[44:47], s52 offen offset:0 sc0 sc1 nt
    buffer_load_dwordx4 v[132:135], v4, s[44:47], s52 offen offset:128 sc0 sc1 nt
    s_waitcnt vmcnt(10)
    buffer_load_dwordx4 v[136:139], v4, s[44:47], s52 offen offset:256 sc0 sc1 nt
    buffer_load_dwordx4 v[140:143], v4, s[44:47], s52 offen offset:384 sc0 sc1 nt
    s_add_u32 s52, s52, 32768
    v_mfma_f32_16x16x32_bf16 v[8:11], v[80:83], v[56:59], 0
    v_mfma_f32_16x16x32_bf16 v[8:11], v[84:87], v[60:63], v[8:11]
    v_mfma_f32_16x16x32_bf16 v[8:11], v[88:91], v[64:67], v[8:11]
    v_mfma_f32_16x16x32_bf16 v[8:11], v[92:95], v[68:71], v[8:11]
    s_cbranch_vccnz L_bo1
    s_waitcnt vmcnt(8)
L_bo1:
    buffer_load_dwordx4 v[80:83], v3, s[44:47], s52 offen offset:0 sc0 sc1 nt
    buffer_load_dwordx4 v[84:87], v3, s[44:47], s52 offen offset:128 sc0 sc1 nt
    s_waitcnt vmcnt(10)
    buffer_load_dwordx4 v[88:91], v3, s[44:47], s52 offen offset:256 sc0 sc1 nt
    buffer_load_dwordx4 v[92:95], v3, s[44:47], s52 offen offset:384 sc0 sc1 nt
    v_mfma_f32_16x16x32_bf16 v[12:15], v[96:99], v[56:59], 0
    v_mfma_f32_16x16x32_bf16 v[12:15], v[100:103], v[60:63], v[12:15]
    v_mfma_f32_16x16x32_bf16 v[12:15], v[104:107], v[64:67], v[12:15]
    v_mfma_f32_16x16x32_bf16 v[12:15], v[108:111], v[68:71], v[12:15]
    s_nop 7
    v_permlane32_swap_b32 v8, v12
    v_permlane32_swap_b32 v9, v13
    v_permlane32_swap_b32 v10, v14
    v_permlane32_swap_b32 v11, v15
    v_mov_b32_dpp v16, v12 quad_perm:[2,3,2,3] row_mask:0xf bank_mask:0xf
    v_mov_b32_dpp v17, v13 quad_perm:[2,3,2,3] row_mask:0xf bank_mask:0xf
    v_mov_b32_dpp v18, v14 quad_perm:[2,3,2,3] row_mask:0xf bank_mask:0xf
    v_mov_b32_dpp v19, v15 quad_perm:[2,3,2,3] row_mask:0xf bank_mask:0xf
    v_add_f32_dpp v8, v8, v16 quad_perm:[0,1,0,1] row_mask:0xf bank_mask:0xf
    v_add_f32_dpp v9, v9, v17 quad_perm:[0,1,0,1] row_mask:0xf bank_mask:0xf
    v_add_f32_dpp v10, v10, v18 quad_perm:[0,1,0,1] row_mask:0xf bank_mask:0xf
    v_add_f32_dpp v11, v11, v19 quad_perm:[0,1,0,1] row_mask:0xf bank_mask:0xf
    v_cvt_pk_bf16_f32 v16, v8, v9
    v_cvt_pk_bf16_f32 v17, v10, v11
    s_mov_b64 exec, s[64:65]
    ds_write_b64 v76, v[16:17] offset:0
    s_mov_b64 exec, -1
    v_max3_f32 v6, v6, v8, v9
    v_max3_f32 v6, v6, v10, v11
    s_cbranch_vccnz L_bo2
    s_waitcnt vmcnt(8)
L_bo2:
    buffer_load_dwordx4 v[96:99], v4, s[44:47], s52 offen offset:0 sc0 sc1 nt
    buffer_load_dwordx4 v[100:103], v4, s[44:47], s52 offen offset:128 sc0 sc1 nt
    s_waitcnt vmcnt(10)
    buffer_load_dwordx4 v[104:107], v4, s[44:47], s52 offen offset:256 sc0 sc1 nt
    buffer_load_dwordx4 v[108:111], v4, s[44:47], s52 offen offset:384 sc0 sc1 nt
    s_add_u32 s52, s52, 32768
    v_mfma_f32_16x16x32_bf16 v[8:11], v[112:115], v[56:59], 0
    v_mfma_f32_16x16x32_bf16 v[8:11], v[116:119], v[60:63], v[8:11]
    v_mfma_f32_16x16x32_bf16 v[8:11], v[120:123], v[64:67], v[8:11]
    v_mfma_f32_16x16x32_bf16 v[8:11], v[124:127], v[68:71], v[8:11]
    s_cbranch_vccnz L_bo3
    s_waitcnt vmcnt(8)
L_bo3:
    buffer_load_dwordx4 v[112:115], v3, s[44:47], s52 offen offset:0 sc0 sc1 nt
    buffer_load_dwordx4 v[116:119], v3, s[44:47], s52 offen offset:128 sc0 sc1 nt
    s_waitcnt vmcnt(10)
    buffer_load_dwordx4 v[120:123], v3, s[44:47], s52 offen offset:256 sc0 sc1 nt
    buffer_load_dwordx4 v[124:127], v3, s[44:47], s52 offen offset:384 sc0 sc1 nt
    v_mfma_f32_16x16x32_bf16 v[12:15], v[128:131], v[56:59], 0
    v_mfma_f32_16x16x32_bf16 v[12:15], v[132:135], v[60:63], v[12:15]
    v_mfma_f32_16x16x32_bf16 v[12:15], v[136:139], v[64:67], v[12:15]
    v_mfma_f32_16x16x32_bf16 v[12:15], v[140:143], v[68:71], v[12:15]
    s_nop 7
    v_permlane32_swap_b32 v8, v12
    v_permlane32_swap_b32 v9, v13
    v_permlane32_swap_b32 v10, v14
    v_permlane32_swap_b32 v11, v15
    v_mov_b32_dpp v16, v12 quad_perm:[2,3,2,3] row_mask:0xf bank_mask:0xf
    v_mov_b32_dpp v17, v13 quad_perm:[2,3,2,3] row_mask:0xf bank_mask:0xf
    v_mov_b32_dpp v18, v14 quad_perm:[2,3,2,3] row_mask:0xf bank_mask:0xf
    v_mov_b32_dpp v19, v15 quad_perm:[2,3,2,3] row_mask:0xf bank_mask:0xf
    v_add_f32_dpp v8, v8, v16 quad_perm:[0,1,0,1] row_mask:0xf bank_mask:0xf
    v_add_f32_dpp v9, v9, v17 quad_perm:[0,1,0,1] row_mask:0xf bank_mask:0xf
    v_add_f32_dpp v10, v10, v18 quad_perm:[0,1,0,1] row_mask:0xf bank_mask:0xf
    v_add_f32_dpp v11, v11, v19 quad_perm:[0,1,0,1] row_mask:0xf bank_mask:0xf
    v_cvt_pk_bf16_f32 v16, v8, v9
    v_cvt_pk_bf16_f32 v17, v10, v11
    s_mov_b64 exec, s[64:65]
    ds_write_b64 v76, v[16:17] offset:64
    s_mov_b64 exec, -1
    v_max3_f32 v6, v6, v8, v9
    v_max3_f32 v6, v6, v10, v11
    v_add_u32 v76, 128, v76
    s_sub_u32 s54, s54, 1
    s_cmp_lg_u32 s54, 0
    s_cbranch_scc1 L_kloop
    s_waitcnt vmcnt(8)
    buffer_load_dwordx4 v[128:131], v4, s[44:47], s52 offen offset:0 sc0 sc1 nt
    buffer_load_dwordx4 v[132:135], v4, s[44:47], s52 offen offset:128 sc0 sc1 nt
    buffer_load_dwordx4 v[136:139], v4, s[44:47], s52 offen offset:256 sc0 sc1 nt
    buffer_load_dwordx4 v[140:143], v4, s[44:47], s52 offen offset:384 sc0 sc1 nt
    s_add_u32 s52, s52, 32768
    v_mfma_f32_16x16x32_bf16 v[8:11], v[80:83], v[56:59], 0
    v_mfma_f32_16x16x32_bf16 v[8:11], v[84:87], v[60:63], v[8:11]
    v_mfma_f32_16x16x32_bf16 v[8:11], v[88:91], v[64:67], v[8:11]
    v_mfma_f32_16x16x32_bf16 v[8:11], v[92:95], v[68:71], v[8:11]
    s_waitcnt vmcnt(8)
    buffer_load_dwordx4 v[80:83], v5, s[48:51], s53 offen offset:0 sc0 sc1 nt
    buffer_load_dwordx4 v[84:87], v5, s[48:51], s53 offen offset:512 sc0 sc1 nt
    buffer_load_dwordx4 v[88:91], v5, s[48:51], s53 offen offset:1024 sc0 sc1 nt
    buffer_load_dwordx4 v[92:95], v5, s[48:51], s53 offen offset:1536 sc0 sc1 nt
    v_mfma_f32_16x16x32_bf16 v[12:15], v[96:99], v[56:59], 0
    v_mfma_f32_16x16x32_bf16 v[12:15], v[100:103], v[60:63], v[12:15]
    v_mfma_f32_16x16x32_bf16 v[12:15], v[104:107], v[64:67], v[12:15]
    v_mfma_f32_16x16x32_bf16 v[12:15], v[108:111], v[68:71], v[12:15]
    s_nop 7
    v_permlane32_swap_b32 v8, v12
    v_permlane32_swap_b32 v9, v13
    v_permlane32_swap_b32 v10, v14
    v_permlane32_swap_b32 v11, v15
    v_mov_b32_dpp v16, v12 quad_perm:[2,3,2,3] row_mask:0xf bank_mask:0xf
    v_mov_b32_dpp v17, v13 quad_perm:[2,3,2,3] row_mask:0xf bank_mask:0xf
    v_mov_b32_dpp v18, v14 quad_perm:[2,3,2,3] row_mask:0xf bank_mask:0xf
    v_mov_b32_dpp v19, v15 quad_perm:[2,3,2,3] row_mask:0xf bank_mask:0xf
    v_add_f32_dpp v8, v8, v16 quad_perm:[0,1,0,1] row_mask:0xf bank_mask:0xf
    v_add_f32_dpp v9, v9, v17 quad_perm:[0,1,0,1] row_mask:0xf bank_mask:0xf
    v_add_f32_dpp v10, v10, v18 quad_perm:[0,1,0,1] row_mask:0xf bank_mask:0xf
    v_add_f32_dpp v11, v11, v19 quad_perm:[0,1,0,1] row_mask:0xf bank_mask:0xf
    v_cvt_pk_bf16_f32 v16, v8, v9
    v_cvt_pk_bf16_f32 v17, v10, v11
    s_mov_b64 exec, s[64:65]
    ds_write_b64 v76, v[16:17] offset:0
    s_mov_b64 exec, -1
    v_max3_f32 v6, v6, v8, v9
    v_max3_f32 v6, v6, v10, v11
    s_waitcnt vmcnt(8)
    buffer_load_dwordx4 v[96:99], v5, s[48:51], s53 offen offset:256 sc0 sc1 nt
    buffer_load_dwordx4 v[100:103], v5, s[48:51], s53 offen offset:768 sc0 sc1 nt
    buffer_load_dwordx4 v[104:107], v5, s[48:51], s53 offen offset:1280 sc0 sc1 nt
    buffer_load_dwordx4 v[108:111], v5, s[48:51], s53 offen offset:1792 sc0 sc1 nt
    s_add_u32 s53, s53, 32768
    v_mfma_f32_16x16x32_bf16 v[8:11], v[112:115], v[56:59], 0
    v_mfma_f32_16x16x32_bf16 v[8:11], v[116:119], v[60:63], v[8:11]
    v_mfma_f32_16x16x32_bf16 v[8:11], v[120:123], v[64:67], v[8:11]
    v_mfma_f32_16x16x32_bf16 v[8:11], v[124:127], v[68:71], v[8:11]
    s_waitcnt vmcnt(8)
    buffer_load_dwordx4 v[112:115], v5, s[48:51], s53 offen offset:0 sc0 sc1 nt
    buffer_load_dwordx4 v[116:119], v5, s[48:51], s53 offen offset:512 sc0 sc1 nt
    buffer_load_dwordx4 v[120:123], v5, s[48:51], s53 offen offset:1024 sc0 sc1 nt
    buffer_load_dwordx4 v[124:127], v5, s[48:51], s53 offen offset:1536 sc0 sc1 nt
    v_mfma_f32_16x16x32_bf16 v[12:15], v[128:131], v[56:59], 0
    v_mfma_f32_16x16x32_bf16 v[12:15], v[132:135], v[60:63], v[12:15]
    v_mfma_f32_16x16x32_bf16 v[12:15], v[136:139], v[64:67], v[12:15]
    v_mfma_f32_16x16x32_bf16 v[12:15], v[140:143], v[68:71], v[12:15]
    s_nop 7
    v_permlane32_swap_b32 v8, v12
    v_permlane32_swap_b32 v9, v13
    v_permlane32_swap_b32 v10, v14
    v_permlane32_swap_b32 v11, v15
    v_mov_b32_dpp v16, v12 quad_perm:[2,3,2,3] row_mask:0xf bank_mask:0xf
    v_mov_b32_dpp v17, v13 quad_perm:[2,3,2,3] row_mask:0xf bank_mask:0xf
    v_mov_b32_dpp v18, v14 quad_perm:[2,3,2,3] row_mask:0xf bank_mask:0xf
    v_mov_b32_dpp v19, v15 quad_perm:[2,3,2,3] row_mask:0xf bank_mask:0xf
    v_add_f32_dpp v8, v8, v16 quad_perm:[0,1,0,1] row_mask:0xf bank_mask:0xf
    v_add_f32_dpp v9, v9, v17 quad_perm:[0,1,0,1] row_mask:0xf bank_mask:0xf
    v_add_f32_dpp v10, v10, v18 quad_perm:[0,1,0,1] row_mask:0xf bank_mask:0xf
    v_add_f32_dpp v11, v11, v19 quad_perm:[0,1,0,1] row_mask:0xf bank_mask:0xf
    v_cvt_pk_bf16_f32 v16, v8, v9
    v_cvt_pk_bf16_f32 v17, v10, v11
    s_mov_b64 exec, s[64:65]
    ds_write_b64 v76, v[16:17] offset:64
    s_mov_b64 exec, -1
    v_max3_f32 v6, v6, v8, v9
    v_max3_f32 v6, v6, v10, v11
    v_subrev_u32 v76, 3456, v76
    s_add_u32 s52, s52, 131072
    s_mov_b32 s60, 0x100000
L_xwait:
    ds_read2st64_b32 v[16:17], v78 offset0:0 offset1:2
    s_waitcnt lgkmcnt(0)
    v_cmp_ne_u32 vcc, 1, v17
    s_cbranch_vccz L_xok
    s_sub_u32 s60, s60, 1
    s_cmp_lg_u32 s60, 0
    s_cbranch_scc1 L_xwait
L_xok:
    ds_read_b32 v16, v78
    s_waitcnt lgkmcnt(0)
    v_max_f32 v6, v6, v16
    s_waitcnt lgkmcnt(0)
    ds_read_b64 v[72:73], v76 offset:0
    v_mov_b32 v16, v6
    s_nop 1
    v_permlane16_swap_b32 v6, v16
    v_max_f32 v6, v6, v16
    v_mov_b32 v16, v6
    s_nop 1
    v_permlane32_swap_b32 v6, v16
    v_max_f32 v6, v6, v16
    v_cvt_pk_bf16_f32 v16, v6, v6
    v_lshlrev_b32 v6, 16, v16
    v_mul_f32 v21, s82, v6
    s_mov_b32 s54, 29
L_vloop:
    s_waitcnt vmcnt(8)
    buffer_load_dwordx4 v[128:131], v5, s[48:51], s53 offen offset:256 sc0 sc1 nt
    buffer_load_dwordx4 v[132:135], v5, s[48:51], s53 offen offset:768 sc0 sc1 nt
    buffer_load_dwordx4 v[136:139], v5, s[48:51], s53 offen offset:1280 sc0 sc1 nt
    buffer_load_dwordx4 v[140:143], v5, s[48:51], s53 offen offset:1792 sc0 sc1 nt
    s_add_u32 s53, s53, 32768
    s_waitcnt lgkmcnt(0)
    ds_read_b64 v[74:75], v76 offset:64
    v_lshlrev_b32 v8, 16, v72
    v_and_b32 v9, 0xffff0000, v72
    v_lshlrev_b32 v10, 16, v73
    v_and_b32 v11, 0xffff0000, v73
    v_fma_f32 v8, v8, s82, -v21
    v_fma_f32 v9, v9, s82, -v21
    v_fma_f32 v10, v10, s82, -v21
    v_fma_f32 v11, v11, s82, -v21
    v_exp_f32 v8, v8
    v_exp_f32 v9, v9
    v_exp_f32 v10, v10
    v_exp_f32 v11, v11
    v_cvt_pk_bf16_f32 v22, v8, v9
    v_cvt_pk_bf16_f32 v23, v10, v11
    v_add_f32 v16, v8, v9
    v_add_f32 v17, v10, v11
    v_add_f32 v16, v16, v17
    v_add_f32 v7, v7, v16
    v_cndmask_b32_e64 v24, 0, v22, s[64:65]
    v_cndmask_b32_e64 v25, 0, v23, s[64:65]
    v_cndmask_b32_e64 v26, 0, v22, s[66:67]
    v_cndmask_b32_e64 v27, 0, v23, s[66:67]
    v_cndmask_b32_e64 v28, 0, v22, s[68:69]
    v_cndmask_b32_e64 v29, 0, v23, s[68:69]
    v_cndmask_b32_e64 v30, 0, v22, s[70:71]
    v_cndmask_b32_e64 v31, 0, v23, s[70:71]
    v_cndmask_b32_e64 v32, 0, v22, s[72:73]
    v_cndmask_b32_e64 v33, 0, v23, s[72:73]
    v_cndmask_b32_e64 v34, 0, v22, s[74:75]
    v_cndmask_b32_e64 v35, 0, v23, s[74:75]
    v_cndmask_b32_e64 v36, 0, v22, s[76:77]
    v_cndmask_b32_e64 v37, 0, v23, s[76:77]
    v_cndmask_b32_e64 v38, 0, v22, s[78:79]
    v_cndmask_b32_e64 v39, 0, v23, s[78:79]
    v_perm_b32 v40, v84, v80, s80
    v_perm_b32 v41, v92, v88, s80
    v_perm_b32 v42, v84, v80, s81
    v_perm_b32 v43, v92, v88, s81
    v_mfma_f32_16x16x16_bf16 v[48:51], v[40:41], v[24:25], v[48:51]
    v_perm_b32 v44, v85, v81, s80
    v_perm_b32 v45, v93, v89, s80
    v_mfma_f32_16x16x16_bf16 v[48:51], v[42:43], v[26:27], v[48:51]
    v_perm_b32 v46, v85, v81, s81
    v_perm_b32 v47, v93, v89, s81
    v_mfma_f32_16x16x16_bf16 v[48:51], v[44:45], v[28:29], v[48:51]
    v_perm_b32 v40, v86, v82, s80
    v_perm_b32 v41, v94, v90, s80
    v_mfma_f32_16x16x16_bf16 v[48:51], v[46:47], v[30:31], v[48:51]
    v_perm_b32 v42, v86, v82, s81
    v_perm_b32 v43, v94, v90, s81
    v_mfma_f32_16x16x16_bf16 v[48:51], v[40:41], v[32:33], v[48:51]
    v_perm_b32 v44, v87, v83, s80
    v_perm_b32 v45, v95, v91, s80
    v_mfma_f32_16x16x16_bf16 v[48:51], v[42:43], v[34:35], v[48:51]
    v_perm_b32 v46, v87, v83, s81
    v_perm_b32 v47, v95, v91, s81
    v_mfma_f32_16x16x16_bf16 v[48:51], v[44:45], v[36:37], v[48:51]
    s_nop 0
    v_mfma_f32_16x16x16_bf16 v[48:51], v[46:47], v[38:39], v[48:51]
    s_waitcnt vmcnt(8)
    buffer_load_dwordx4 v[80:83], v5, s[48:51], s53 offen offset:0 sc0 sc1 nt
    buffer_load_dwordx4 v[84:87], v5, s[48:51], s53 offen offset:512 sc0 sc1 nt
    buffer_load_dwordx4 v[88:91], v5, s[48:51], s53 offen offset:1024 sc0 sc1 nt
    buffer_load_dwordx4 v[92:95], v5, s[48:51], s53 offen offset:1536 sc0 sc1 nt
    v_perm_b32 v40, v100, v96, s80
    v_perm_b32 v41, v108, v104, s80
    v_perm_b32 v42, v100, v96, s81
    v_perm_b32 v43, v108, v104, s81
    v_mfma_f32_16x16x16_bf16 v[52:55], v[40:41], v[24:25], v[52:55]
    v_perm_b32 v44, v101, v97, s80
    v_perm_b32 v45, v109, v105, s80
    v_mfma_f32_16x16x16_bf16 v[52:55], v[42:43], v[26:27], v[52:55]
    v_perm_b32 v46, v101, v97, s81
    v_perm_b32 v47, v109, v105, s81
    v_mfma_f32_16x16x16_bf16 v[52:55], v[44:45], v[28:29], v[52:55]
    v_perm_b32 v40, v102, v98, s80
    v_perm_b32 v41, v110, v106, s80
    v_mfma_f32_16x16x16_bf16 v[52:55], v[46:47], v[30:31], v[52:55]
    v_perm_b32 v42, v102, v98, s81
    v_perm_b32 v43, v110, v106, s81
    v_mfma_f32_16x16x16_bf16 v[52:55], v[40:41], v[32:33], v[52:55]
    v_perm_b32 v44, v103, v99, s80
    v_perm_b32 v45, v111, v107, s80
    v_mfma_f32_16x16x16_bf16 v[52:55], v[42:43], v[34:35], v[52:55]
    v_perm_b32 v46, v103, v99, s81
    v_perm_b32 v47, v111, v107, s81
    v_mfma_f32_16x16x16_bf16 v[52:55], v[44:45], v[36:37], v[52:55]
    s_nop 0
    v_mfma_f32_16x16x16_bf16 v[52:55], v[46:47], v[38:39], v[52:55]
    s_waitcnt vmcnt(8)
    buffer_load_dwordx4 v[96:99], v5, s[48:51], s53 offen offset:256 sc0 sc1 nt
    buffer_load_dwordx4 v[100:103], v5, s[48:51], s53 offen offset:768 sc0 sc1 nt
    buffer_load_dwordx4 v[104:107], v5, s[48:51], s53 offen offset:1280 sc0 sc1 nt
    buffer_load_dwordx4 v[108:111], v5, s[48:51], s53 offen offset:1792 sc0 sc1 nt
    s_add_u32 s53, s53, 32768
    s_waitcnt lgkmcnt(0)
    ds_read_b64 v[72:73], v76 offset:128
    v_lshlrev_b32 v8, 16, v74
    v_and_b32 v9, 0xffff0000, v74
    v_lshlrev_b32 v10, 16, v75
    v_and_b32 v11, 0xffff0000, v75
    v_fma_f32 v8, v8, s82, -v21
    v_fma_f32 v9, v9, s82, -v21
    v_fma_f32 v10, v10, s82, -v21
    v_fma_f32 v11, v11, s82, -v21
    v_exp_f32 v8, v8
    v_exp_f32 v9, v9
    v_exp_f32 v10, v10
    v_exp_f32 v11, v11
    v_cvt_pk_bf16_f32 v22, v8, v9
    v_cvt_pk_bf16_f32 v23, v10, v11
    v_add_f32 v16, v8, v9
    v_add_f32 v17, v10, v11
    v_add_f32 v16, v16, v17
    v_add_f32 v7, v7, v16
    v_cndmask_b32_e64 v24, 0, v22, s[64:65]
    v_cndmask_b32_e64 v25, 0, v23, s[64:65]
    v_cndmask_b32_e64 v26, 0, v22, s[66:67]
    v_cndmask_b32_e64 v27, 0, v23, s[66:67]
    v_cndmask_b32_e64 v28, 0, v22, s[68:69]
    v_cndmask_b32_e64 v29, 0, v23, s[68:69]
    v_cndmask_b32_e64 v30, 0, v22, s[70:71]
    v_cndmask_b32_e64 v31, 0, v23, s[70:71]
    v_cndmask_b32_e64 v32, 0, v22, s[72:73]
    v_cndmask_b32_e64 v33, 0, v23, s[72:73]
    v_cndmask_b32_e64 v34, 0, v22, s[74:75]
    v_cndmask_b32_e64 v35, 0, v23, s[74:75]
    v_cndmask_b32_e64 v36, 0, v22, s[76:77]
    v_cndmask_b32_e64 v37, 0, v23, s[76:77]
    v_cndmask_b32_e64 v38, 0, v22, s[78:79]
    v_cndmask_b32_e64 v39, 0, v23, s[78:79]
    v_perm_b32 v40, v116, v112, s80
    v_perm_b32 v41, v124, v120, s80
    v_perm_b32 v42, v116, v112, s81
    v_perm_b32 v43, v124, v120, s81
    v_mfma_f32_16x16x16_bf16 v[48:51], v[40:41], v[24:25], v[48:51]
    v_perm_b32 v44, v117, v113, s80
    v_perm_b32 v45, v125, v121, s80
    v_mfma_f32_16x16x16_bf16 v[48:51], v[42:43], v[26:27], v[48:51]
    v_perm_b32 v46, v117, v113, s81
    v_perm_b32 v47, v125, v121, s81
    v_mfma_f32_16x16x16_bf16 v[48:51], v[44:45], v[28:29], v[48:51]
    v_perm_b32 v40, v118, v114, s80
    v_perm_b32 v41, v126, v122, s80
    v_mfma_f32_16x16x16_bf16 v[48:51], v[46:47], v[30:31], v[48:51]
    v_perm_b32 v42, v118, v114, s81
    v_perm_b32 v43, v126, v122, s81
    v_mfma_f32_16x16x16_bf16 v[48:51], v[40:41], v[32:33], v[48:51]
    v_perm_b32 v44, v119, v115, s80
    v_perm_b32 v45, v127, v123, s80
    v_mfma_f32_16x16x16_bf16 v[48:51], v[42:43], v[34:35], v[48:51]
    v_perm_b32 v46, v119, v115, s81
    v_perm_b32 v47, v127, v123, s81
    v_mfma_f32_16x16x16_bf16 v[48:51], v[44:45], v[36:37], v[48:51]
    s_nop 0
    v_mfma_f32_16x16x16_bf16 v[48:51], v[46:47], v[38:39], v[48:51]
    s_waitcnt vmcnt(8)
    buffer_load_dwordx4 v[112:115], v5, s[48:51], s53 offen offset:0 sc0 sc1 nt
    buffer_load_dwordx4 v[116:119], v5, s[48:51], s53 offen offset:512 sc0 sc1 nt
    buffer_load_dwordx4 v[120:123], v5, s[48:51], s53 offen offset:1024 sc0 sc1 nt
    buffer_load_dwordx4 v[124:127], v5, s[48:51], s53 offen offset:1536 sc0 sc1 nt
    v_perm_b32 v40, v132, v128, s80
    v_perm_b32 v41, v140, v136, s80
    v_perm_b32 v42, v132, v128, s81
    v_perm_b32 v43, v140, v136, s81
    v_mfma_f32_16x16x16_bf16 v[52:55], v[40:41], v[24:25], v[52:55]
    v_perm_b32 v44, v133, v129, s80
    v_perm_b32 v45, v141, v137, s80
    v_mfma_f32_16x16x16_bf16 v[52:55], v[42:43], v[26:27], v[52:55]
    v_perm_b32 v46, v133, v129, s81
    v_perm_b32 v47, v141, v137, s81
    v_mfma_f32_16x16x16_bf16 v[52:55], v[44:45], v[28:29], v[52:55]
    v_perm_b32 v40, v134, v130, s80
    v_perm_b32 v41, v142, v138, s80
    v_mfma_f32_16x16x16_bf16 v[52:55], v[46:47], v[30:31], v[52:55]
    v_perm_b32 v42, v134, v130, s81
    v_perm_b32 v43, v142, v138, s81
    v_mfma_f32_16x16x16_bf16 v[52:55], v[40:41], v[32:33], v[52:55]
    v_perm_b32 v44, v135, v131, s80
    v_perm_b32 v45, v143, v139, s80
    v_mfma_f32_16x16x16_bf16 v[52:55], v[42:43], v[34:35], v[52:55]
    v_perm_b32 v46, v135, v131, s81
    v_perm_b32 v47, v143, v139, s81
    v_mfma_f32_16x16x16_bf16 v[52:55], v[44:45], v[36:37], v[52:55]
    s_nop 0
    v_mfma_f32_16x16x16_bf16 v[52:55], v[46:47], v[38:39], v[52:55]
    v_add_u32 v76, 128, v76
    s_sub_u32 s54, s54, 1
    s_cmp_lg_u32 s54, 0
    s_cbranch_scc1 L_vloop
    s_waitcnt vmcnt(8)
    buffer_load_dwordx4 v[128:131], v5, s[48:51], s53 offen offset:256 sc0 sc1 nt
    buffer_load_dwordx4 v[132:135], v5, s[48:51], s53 offen offset:768 sc0 sc1 nt
    buffer_load_dwordx4 v[136:139], v5, s[48:51], s53 offen offset:1280 sc0 sc1 nt
    buffer_load_dwordx4 v[140:143], v5, s[48:51], s53 offen offset:1792 sc0 sc1 nt
    s_add_u32 s53, s53, 32768
    s_waitcnt lgkmcnt(0)
    ds_read_b64 v[74:75], v76 offset:64
    v_lshlrev_b32 v8, 16, v72
    v_and_b32 v9, 0xffff0000, v72
    v_lshlrev_b32 v10, 16, v73
    v_and_b32 v11, 0xffff0000, v73
    v_fma_f32 v8, v8, s82, -v21
    v_fma_f32 v9, v9, s82, -v21
    v_fma_f32 v10, v10, s82, -v21
    v_fma_f32 v11, v11, s82, -v21
    v_exp_f32 v8, v8
    v_exp_f32 v9, v9
    v_exp_f32 v10, v10
    v_exp_f32 v11, v11
    v_cvt_pk_bf16_f32 v22, v8, v9
    v_cvt_pk_bf16_f32 v23, v10, v11
    v_add_f32 v16, v8, v9
    v_add_f32 v17, v10, v11
    v_add_f32 v16, v16, v17
    v_add_f32 v7, v7, v16
    v_cndmask_b32_e64 v24, 0, v22, s[64:65]
    v_cndmask_b32_e64 v25, 0, v23, s[64:65]
    v_cndmask_b32_e64 v26, 0, v22, s[66:67]
    v_cndmask_b32_e64 v27, 0, v23, s[66:67]
    v_cndmask_b32_e64 v28, 0, v22, s[68:69]
    v_cndmask_b32_e64 v29, 0, v23, s[68:69]
    v_cndmask_b32_e64 v30, 0, v22, s[70:71]
    v_cndmask_b32_e64 v31, 0, v23, s[70:71]
    v_cndmask_b32_e64 v32, 0, v22, s[72:73]
    v_cndmask_b32_e64 v33, 0, v23, s[72:73]
    v_cndmask_b32_e64 v34, 0, v22, s[74:75]
    v_cndmask_b32_e64 v35, 0, v23, s[74:75]
    v_cndmask_b32_e64 v36, 0, v22, s[76:77]
    v_cndmask_b32_e64 v37, 0, v23, s[76:77]
    v_cndmask_b32_e64 v38, 0, v22, s[78:79]
    v_cndmask_b32_e64 v39, 0, v23, s[78:79]
    v_perm_b32 v40, v84, v80, s80
    v_perm_b32 v41, v92, v88, s80
    v_perm_b32 v42, v84, v80, s81
    v_perm_b32 v43, v92, v88, s81
    v_mfma_f32_16x16x16_bf16 v[48:51], v[40:41], v[24:25], v[48:51]
    v_perm_b32 v44, v85, v81, s80
    v_perm_b32 v45, v93, v89, s80
    v_mfma_f32_16x16x16_bf16 v[48:51], v[42:43], v[26:27], v[48:51]
    v_perm_b32 v46, v85, v81, s81
    v_perm_b32 v47, v93, v89, s81
    v_mfma_f32_16x16x16_bf16 v[48:51], v[44:45], v[28:29], v[48:51]
    v_perm_b32 v40, v86, v82, s80
    v_perm_b32 v41, v94, v90, s80
    v_mfma_f32_16x16x16_bf16 v[48:51], v[46:47], v[30:31], v[48:51]
    v_perm_b32 v42, v86, v82, s81
    v_perm_b32 v43, v94, v90, s81
    v_mfma_f32_16x16x16_bf16 v[48:51], v[40:41], v[32:33], v[48:51]
    v_perm_b32 v44, v87, v83, s80
    v_perm_b32 v45, v95, v91, s80
    v_mfma_f32_16x16x16_bf16 v[48:51], v[42:43], v[34:35], v[48:51]
    v_perm_b32 v46, v87, v83, s81
    v_perm_b32 v47, v95, v91, s81
    v_mfma_f32_16x16x16_bf16 v[48:51], v[44:45], v[36:37], v[48:51]
    s_nop 0
    v_mfma_f32_16x16x16_bf16 v[48:51], v[46:47], v[38:39], v[48:51]
    s_waitcnt vmcnt(8)
    buffer_load_dwordx4 v[80:83], v3, s[44:47], s52 offen offset:0 sc0 sc1 nt
    buffer_load_dwordx4 v[84:87], v3, s[44:47], s52 offen offset:128 sc0 sc1 nt
    buffer_load_dwordx4 v[88:91], v3, s[44:47], s52 offen offset:256 sc0 sc1 nt
    buffer_load_dwordx4 v[92:95], v3, s[44:47], s52 offen offset:384 sc0 sc1 nt
    v_perm_b32 v40, v100, v96, s80
    v_perm_b32 v41, v108, v104, s80
    v_perm_b32 v42, v100, v96, s81
    v_perm_b32 v43, v108, v104, s81
    v_mfma_f32_16x16x16_bf16 v[52:55], v[40:41], v[24:25], v[52:55]
    v_perm_b32 v44, v101, v97, s80
    v_perm_b32 v45, v109, v105, s80
    v_mfma_f32_16x16x16_bf16 v[52:55], v[42:43], v[26:27], v[52:55]
    v_perm_b32 v46, v101, v97, s81
    v_perm_b32 v47, v109, v105, s81
    v_mfma_f32_16x16x16_bf16 v[52:55], v[44:45], v[28:29], v[52:55]
    v_perm_b32 v40, v102, v98, s80
    v_perm_b32 v41, v110, v106, s80
    v_mfma_f32_16x16x16_bf16 v[52:55], v[46:47], v[30:31], v[52:55]
    v_perm_b32 v42, v102, v98, s81
    v_perm_b32 v43, v110, v106, s81
    v_mfma_f32_16x16x16_bf16 v[52:55], v[40:41], v[32:33], v[52:55]
    v_perm_b32 v44, v103, v99, s80
    v_perm_b32 v45, v111, v107, s80
    v_mfma_f32_16x16x16_bf16 v[52:55], v[42:43], v[34:35], v[52:55]
    v_perm_b32 v46, v103, v99, s81
    v_perm_b32 v47, v111, v107, s81
    v_mfma_f32_16x16x16_bf16 v[52:55], v[44:45], v[36:37], v[52:55]
    s_nop 0
    v_mfma_f32_16x16x16_bf16 v[52:55], v[46:47], v[38:39], v[52:55]
    s_waitcnt vmcnt(8)
    buffer_load_dwordx4 v[96:99], v4, s[44:47], s52 offen offset:0 sc0 sc1 nt
    buffer_load_dwordx4 v[100:103], v4, s[44:47], s52 offen offset:128 sc0 sc1 nt
    buffer_load_dwordx4 v[104:107], v4, s[44:47], s52 offen offset:256 sc0 sc1 nt
    buffer_load_dwordx4 v[108:111], v4, s[44:47], s52 offen offset:384 sc0 sc1 nt
    s_add_u32 s52, s52, 32768
    s_waitcnt lgkmcnt(0)
    s_mov_b32 s61, 1
    s_atomic_add s61, s[98:99], 0x0 glc
    v_lshlrev_b32 v8, 16, v74
    v_and_b32 v9, 0xffff0000, v74
    v_lshlrev_b32 v10, 16, v75
    v_and_b32 v11, 0xffff0000, v75
    v_fma_f32 v8, v8, s82, -v21
    v_fma_f32 v9, v9, s82, -v21
    v_fma_f32 v10, v10, s82, -v21
    v_fma_f32 v11, v11, s82, -v21
    v_exp_f32 v8, v8
    v_exp_f32 v9, v9
    v_exp_f32 v10, v10
    v_exp_f32 v11, v11
    v_cvt_pk_bf16_f32 v22, v8, v9
    v_cvt_pk_bf16_f32 v23, v10, v11
    v_add_f32 v16, v8, v9
    v_add_f32 v17, v10, v11
    v_add_f32 v16, v16, v17
    v_add_f32 v7, v7, v16
    v_cndmask_b32_e64 v24, 0, v22, s[64:65]
    v_cndmask_b32_e64 v25, 0, v23, s[64:65]
    v_cndmask_b32_e64 v26, 0, v22, s[66:67]
    v_cndmask_b32_e64 v27, 0, v23, s[66:67]
    v_cndmask_b32_e64 v28, 0, v22, s[68:69]
    v_cndmask_b32_e64 v29, 0, v23, s[68:69]
    v_cndmask_b32_e64 v30, 0, v22, s[70:71]
    v_cndmask_b32_e64 v31, 0, v23, s[70:71]
    v_cndmask_b32_e64 v32, 0, v22, s[72:73]
    v_cndmask_b32_e64 v33, 0, v23, s[72:73]
    v_cndmask_b32_e64 v34, 0, v22, s[74:75]
    v_cndmask_b32_e64 v35, 0, v23, s[74:75]
    v_cndmask_b32_e64 v36, 0, v22, s[76:77]
    v_cndmask_b32_e64 v37, 0, v23, s[76:77]
    v_cndmask_b32_e64 v38, 0, v22, s[78:79]
    v_cndmask_b32_e64 v39, 0, v23, s[78:79]
    v_perm_b32 v40, v116, v112, s80
    v_perm_b32 v41, v124, v120, s80
    v_perm_b32 v42, v116, v112, s81
    v_perm_b32 v43, v124, v120, s81
    v_mfma_f32_16x16x16_bf16 v[48:51], v[40:41], v[24:25], v[48:51]
    v_perm_b32 v44, v117, v113, s80
    v_perm_b32 v45, v125, v121, s80
    v_mfma_f32_16x16x16_bf16 v[48:51], v[42:43], v[26:27], v[48:51]
    v_perm_b32 v46, v117, v113, s81
    v_perm_b32 v47, v125, v121, s81
    v_mfma_f32_16x16x16_bf16 v[48:51], v[44:45], v[28:29], v[48:51]
    v_perm_b32 v40, v118, v114, s80
    v_perm_b32 v41, v126, v122, s80
    v_mfma_f32_16x16x16_bf16 v[48:51], v[46:47], v[30:31], v[48:51]
    v_perm_b32 v42, v118, v114, s81
    v_perm_b32 v43, v126, v122, s81
    v_mfma_f32_16x16x16_bf16 v[48:51], v[40:41], v[32:33], v[48:51]
    v_perm_b32 v44, v119, v115, s80
    v_perm_b32 v45, v127, v123, s80
    v_mfma_f32_16x16x16_bf16 v[48:51], v[42:43], v[34:35], v[48:51]
    v_perm_b32 v46, v119, v115, s81
    v_perm_b32 v47, v127, v123, s81
    v_mfma_f32_16x16x16_bf16 v[48:51], v[44:45], v[36:37], v[48:51]
    s_nop 0
    v_mfma_f32_16x16x16_bf16 v[48:51], v[46:47], v[38:39], v[48:51]
    s_waitcnt vmcnt(8)
    buffer_load_dwordx4 v[112:115], v5, s[48:51], s53 offen offset:0 sc0 sc1 nt
    buffer_load_dwordx4 v[116:119], v5, s[48:51], s53 offen offset:512 sc0 sc1 nt
    buffer_load_dwordx4 v[120:123], v5, s[48:51], s53 offen offset:1024 sc0 sc1 nt
    buffer_load_dwordx4 v[124:127], v5, s[48:51], s53 offen offset:1536 sc0 sc1 nt
    v_perm_b32 v40, v132, v128, s80
    v_perm_b32 v41, v140, v136, s80
    v_perm_b32 v42, v132, v128, s81
    v_perm_b32 v43, v140, v136, s81
    v_mfma_f32_16x16x16_bf16 v[52:55], v[40:41], v[24:25], v[52:55]
    v_perm_b32 v44, v133, v129, s80
    v_perm_b32 v45, v141, v137, s80
    v_mfma_f32_16x16x16_bf16 v[52:55], v[42:43], v[26:27], v[52:55]
    v_perm_b32 v46, v133, v129, s81
    v_perm_b32 v47, v141, v137, s81
    v_mfma_f32_16x16x16_bf16 v[52:55], v[44:45], v[28:29], v[52:55]
    v_perm_b32 v40, v134, v130, s80
    v_perm_b32 v41, v142, v138, s80
    v_mfma_f32_16x16x16_bf16 v[52:55], v[46:47], v[30:31], v[52:55]
    v_perm_b32 v42, v134, v130, s81
    v_perm_b32 v43, v142, v138, s81
    v_mfma_f32_16x16x16_bf16 v[52:55], v[40:41], v[32:33], v[52:55]
    v_perm_b32 v44, v135, v131, s80
    v_perm_b32 v45, v143, v139, s80
    v_mfma_f32_16x16x16_bf16 v[52:55], v[42:43], v[34:35], v[52:55]
    v_perm_b32 v46, v135, v131, s81
    v_perm_b32 v47, v143, v139, s81
    v_mfma_f32_16x16x16_bf16 v[52:55], v[44:45], v[36:37], v[52:55]
    s_nop 0
    v_mfma_f32_16x16x16_bf16 v[52:55], v[46:47], v[38:39], v[52:55]
L_dyn:
    s_waitcnt vmcnt(8)
    buffer_load_dwordx4 v[128:131], v5, s[48:51], s53 offen offset:256 sc0 sc1 nt
    buffer_load_dwordx4 v[132:135], v5, s[48:51], s53 offen offset:768 sc0 sc1 nt
    buffer_load_dwordx4 v[136:139], v5, s[48:51], s53 offen offset:1280 sc0 sc1 nt
    buffer_load_dwordx4 v[140:143], v5, s[48:51], s53 offen offset:1792 sc0 sc1 nt
    s_add_u32 s53, s53, 32768
    v_mfma_f32_16x16x32_bf16 v[8:11], v[80:83], v[56:59], 0
    v_mfma_f32_16x16x32_bf16 v[8:11], v[84:87], v[60:63], v[8:11]
    v_mfma_f32_16x16x32_bf16 v[8:11], v[88:91], v[64:67], v[8:11]
    v_mfma_f32_16x16x32_bf16 v[8:11], v[92:95], v[68:71], v[8:11]
    s_waitcnt vmcnt(8) lgkmcnt(0)
    s_cmp_ge_u32 s61, 96
    s_cbranch_scc1 L_drain
    s_bfe_u32 s52, s61, 0x30001
    s_lshl_b32 s52, s52, 8
    s_and_b32 s55, s61, 1
    s_add_u32 s52, s52, s55
    s_lshr_b32 s54, s61, 4
    s_lshl_b32 s54, s54, 1
    s_add_u32 s52, s52, s54
    s_add_u32 s52, s52, 244
    s_lshl_b32 s52, s52, 13
    s_mov_b32 s53, s52
    buffer_load_dwordx4 v[80:83], v3, s[44:47], s52 offen offset:0 sc0 sc1 nt
    buffer_load_dwordx4 v[84:87], v3, s[44:47], s52 offen offset:128 sc0 sc1 nt
    buffer_load_dwordx4 v[88:91], v3, s[44:47], s52 offen offset:256 sc0 sc1 nt
    buffer_load_dwordx4 v[92:95], v3, s[44:47], s52 offen offset:384 sc0 sc1 nt
    s_mov_b32 s61, 1
    s_atomic_add s61, s[98:99], 0x0 glc
    v_mfma_f32_16x16x32_bf16 v[12:15], v[96:99], v[56:59], 0
    v_mfma_f32_16x16x32_bf16 v[12:15], v[100:103], v[60:63], v[12:15]
    v_mfma_f32_16x16x32_bf16 v[12:15], v[104:107], v[64:67], v[12:15]
    v_mfma_f32_16x16x32_bf16 v[12:15], v[108:111], v[68:71], v[12:15]
    s_nop 7
    v_permlane32_swap_b32 v8, v12
    v_permlane32_swap_b32 v9, v13
    v_permlane32_swap_b32 v10, v14
    v_permlane32_swap_b32 v11, v15
    v_mov_b32_dpp v16, v12 quad_perm:[2,3,2,3] row_mask:0xf bank_mask:0xf
    v_mov_b32_dpp v17, v13 quad_perm:[2,3,2,3] row_mask:0xf bank_mask:0xf
    v_mov_b32_dpp v18, v14 quad_perm:[2,3,2,3] row_mask:0xf bank_mask:0xf
    v_mov_b32_dpp v19, v15 quad_perm:[2,3,2,3] row_mask:0xf bank_mask:0xf
    v_add_f32_dpp v8, v8, v16 quad_perm:[0,1,0,1] row_mask:0xf bank_mask:0xf
    v_add_f32_dpp v9, v9, v17 quad_perm:[0,1,0,1] row_mask:0xf bank_mask:0xf
    v_add_f32_dpp v10, v10, v18 quad_perm:[0,1,0,1] row_mask:0xf bank_mask:0xf
    v_add_f32_dpp v11, v11, v19 quad_perm:[0,1,0,1] row_mask:0xf bank_mask:0xf
    v_cvt_pk_bf16_f32 v16, v8, v9
    v_cvt_pk_bf16_f32 v17, v10, v11
    v_lshlrev_b32 v8, 16, v16
    v_and_b32 v9, 0xffff0000, v16
    v_lshlrev_b32 v10, 16, v17
    v_and_b32 v11, 0xffff0000, v17
    v_max3_f32 v16, v8, v9, v10
    v_max3_f32 v16, v16, v11, v6
    v_mov_b32 v17, v16
    s_nop 1
    v_permlane16_swap_b32 v16, v17
    v_max_f32 v16, v16, v17
    v_mov_b32 v17, v16
    s_nop 1
    v_permlane32_swap_b32 v16, v17
    v_max_f32 v16, v16, v17
    v_sub_f32 v20, v6, v16
    v_mul_f32 v21, s82, v16
    v_mul_f32 v20, s82, v20
    v_mov_b32 v6, v16
    v_exp_f32 v20, v20
    v_fma_f32 v8, v8, s82, -v21
    v_fma_f32 v9, v9, s82, -v21
    v_fma_f32 v10, v10, s82, -v21
    v_fma_f32 v11, v11, s82, -v21
    v_exp_f32 v8, v8
    v_exp_f32 v9, v9
    v_exp_f32 v10, v10
    v_exp_f32 v11, v11
    v_mul_f32 v48, v48, v20
    v_mul_f32 v49, v49, v20
    v_mul_f32 v50, v50, v20
    v_mul_f32 v51, v51, v20
    v_mul_f32 v52, v52, v20
    v_mul_f32 v53, v53, v20
    v_mul_f32 v54, v54, v20
    v_mul_f32 v55, v55, v20
    v_cvt_pk_bf16_f32 v22, v8, v9
    v_cvt_pk_bf16_f32 v23, v10, v11
    v_add_f32 v16, v8, v9
    v_add_f32 v17, v10, v11
    v_add_f32 v16, v16, v17
    v_fma_f32 v7, v7, v20, v16
    v_cndmask_b32_e64 v24, 0, v22, s[64:65]
    v_cndmask_b32_e64 v25, 0, v23, s[64:65]
    v_cndmask_b32_e64 v26, 0, v22, s[66:67]
    v_cndmask_b32_e64 v27, 0, v23, s[66:67]
    v_cndmask_b32_e64 v28, 0, v22, s[68:69]
    v_cndmask_b32_e64 v29, 0, v23, s[68:69]
    v_cndmask_b32_e64 v30, 0, v22, s[70:71]
    v_cndmask_b32_e64 v31, 0, v23, s[70:71]
    v_cndmask_b32_e64 v32, 0, v22, s[72:73]
    v_cndmask_b32_e64 v33, 0, v23, s[72:73]
    v_cndmask_b32_e64 v34, 0, v22, s[74:75]
    v_cndmask_b32_e64 v35, 0, v23, s[74:75]
    v_cndmask_b32_e64 v36, 0, v22, s[76:77]
    v_cndmask_b32_e64 v37, 0, v23, s[76:77]
    v_cndmask_b32_e64 v38, 0, v22, s[78:79]
    v_cndmask_b32_e64 v39, 0, v23, s[78:79]
    s_waitcnt vmcnt(8)
    buffer_load_dwordx4 v[96:99], v4, s[44:47], s52 offen offset:0 sc0 sc1 nt
    buffer_load_dwordx4 v[100:103], v4, s[44:47], s52 offen offset:128 sc0 sc1 nt
    buffer_load_dwordx4 v[104:107], v4, s[44:47], s52 offen offset:256 sc0 sc1 nt
    buffer_load_dwordx4 v[108:111], v4, s[44:47], s52 offen offset:384 sc0 sc1 nt
    s_add_u32 s52, s52, 32768
    v_perm_b32 v40, v116, v112, s80
    v_perm_b32 v41, v124, v120, s80
    v_perm_b32 v42, v116, v112, s81
    v_perm_b32 v43, v124, v120, s81
    v_mfma_f32_16x16x16_bf16 v[48:51], v[40:41], v[24:25], v[48:51]
    v_perm_b32 v44, v117, v113, s80
    v_perm_b32 v45, v125, v121, s80
    v_mfma_f32_16x16x16_bf16 v[48:51], v[42:43], v[26:27], v[48:51]
    v_perm_b32 v46, v117, v113, s81
    v_perm_b32 v47, v125, v121, s81
    v_mfma_f32_16x16x16_bf16 v[48:51], v[44:45], v[28:29], v[48:51]
    v_perm_b32 v40, v118, v114, s80
    v_perm_b32 v41, v126, v122, s80
    v_mfma_f32_16x16x16_bf16 v[48:51], v[46:47], v[30:31], v[48:51]
    v_perm_b32 v42, v118, v114, s81
    v_perm_b32 v43, v126, v122, s81
    v_mfma_f32_16x16x16_bf16 v[48:51], v[40:41], v[32:33], v[48:51]
    v_perm_b32 v44, v119, v115, s80
    v_perm_b32 v45, v127, v123, s80
    v_mfma_f32_16x16x16_bf16 v[48:51], v[42:43], v[34:35], v[48:51]
    v_perm_b32 v46, v119, v115, s81
    v_perm_b32 v47, v127, v123, s81
    v_mfma_f32_16x16x16_bf16 v[48:51], v[44:45], v[36:37], v[48:51]
    s_nop 0
    v_mfma_f32_16x16x16_bf16 v[48:51], v[46:47], v[38:39], v[48:51]
    s_waitcnt vmcnt(8)
    buffer_load_dwordx4 v[112:115], v5, s[48:51], s53 offen offset:0 sc0 sc1 nt
    buffer_load_dwordx4 v[116:119], v5, s[48:51], s53 offen offset:512 sc0 sc1 nt
    buffer_load_dwordx4 v[120:123], v5, s[48:51], s53 offen offset:1024 sc0 sc1 nt
    buffer_load_dwordx4 v[124:127], v5, s[48:51], s53 offen offset:1536 sc0 sc1 nt
    v_perm_b32 v40, v132, v128, s80
    v_perm_b32 v41, v140, v136, s80
    v_perm_b32 v42, v132, v128, s81
    v_perm_b32 v43, v140, v136, s81
    v_mfma_f32_16x16x16_bf16 v[52:55], v[40:41], v[24:25], v[52:55]
    v_perm_b32 v44, v133, v129, s80
    v_perm_b32 v45, v141, v137, s80
    v_mfma_f32_16x16x16_bf16 v[52:55], v[42:43], v[26:27], v[52:55]
    v_perm_b32 v46, v133, v129, s81
    v_perm_b32 v47, v141, v137, s81
    v_mfma_f32_16x16x16_bf16 v[52:55], v[44:45], v[28:29], v[52:55]
    v_perm_b32 v40, v134, v130, s80
    v_perm_b32 v41, v142, v138, s80
    v_mfma_f32_16x16x16_bf16 v[52:55], v[46:47], v[30:31], v[52:55]
    v_perm_b32 v42, v134, v130, s81
    v_perm_b32 v43, v142, v138, s81
    v_mfma_f32_16x16x16_bf16 v[52:55], v[40:41], v[32:33], v[52:55]
    v_perm_b32 v44, v135, v131, s80
    v_perm_b32 v45, v143, v139, s80
    v_mfma_f32_16x16x16_bf16 v[52:55], v[42:43], v[34:35], v[52:55]
    v_perm_b32 v46, v135, v131, s81
    v_perm_b32 v47, v143, v139, s81
    v_mfma_f32_16x16x16_bf16 v[52:55], v[44:45], v[36:37], v[52:55]
    s_nop 0
    v_mfma_f32_16x16x16_bf16 v[52:55], v[46:47], v[38:39], v[52:55]
    s_branch L_dyn
L_drain:
    v_mfma_f32_16x16x32_bf16 v[12:15], v[96:99], v[56:59], 0
    v_mfma_f32_16x16x32_bf16 v[12:15], v[100:103], v[60:63], v[12:15]
    v_mfma_f32_16x16x32_bf16 v[12:15], v[104:107], v[64:67], v[12:15]
    v_mfma_f32_16x16x32_bf16 v[12:15], v[108:111], v[68:71], v[12:15]
    s_nop 7
    v_permlane32_swap_b32 v8, v12
    v_permlane32_swap_b32 v9, v13
    v_permlane32_swap_b32 v10, v14
    v_permlane32_swap_b32 v11, v15
    v_mov_b32_dpp v16, v12 quad_perm:[2,3,2,3] row_mask:0xf bank_mask:0xf
    v_mov_b32_dpp v17, v13 quad_perm:[2,3,2,3] row_mask:0xf bank_mask:0xf
    v_mov_b32_dpp v18, v14 quad_perm:[2,3,2,3] row_mask:0xf bank_mask:0xf
    v_mov_b32_dpp v19, v15 quad_perm:[2,3,2,3] row_mask:0xf bank_mask:0xf
    v_add_f32_dpp v8, v8, v16 quad_perm:[0,1,0,1] row_mask:0xf bank_mask:0xf
    v_add_f32_dpp v9, v9, v17 quad_perm:[0,1,0,1] row_mask:0xf bank_mask:0xf
    v_add_f32_dpp v10, v10, v18 quad_perm:[0,1,0,1] row_mask:0xf bank_mask:0xf
    v_add_f32_dpp v11, v11, v19 quad_perm:[0,1,0,1] row_mask:0xf bank_mask:0xf
    v_cvt_pk_bf16_f32 v16, v8, v9
    v_cvt_pk_bf16_f32 v17, v10, v11
    v_lshlrev_b32 v8, 16, v16
    v_and_b32 v9, 0xffff0000, v16
    v_lshlrev_b32 v10, 16, v17
    v_and_b32 v11, 0xffff0000, v17
    v_max3_f32 v16, v8, v9, v10
    v_max3_f32 v16, v16, v11, v6
    v_mov_b32 v17, v16
    s_nop 1
    v_permlane16_swap_b32 v16, v17
    v_max_f32 v16, v16, v17
    v_mov_b32 v17, v16
    s_nop 1
    v_permlane32_swap_b32 v16, v17
    v_max_f32 v16, v16, v17
    v_sub_f32 v20, v6, v16
    v_mul_f32 v21, s82, v16
    v_mul_f32 v20, s82, v20
    v_mov_b32 v6, v16
    v_exp_f32 v20, v20
    v_fma_f32 v8, v8, s82, -v21
    v_fma_f32 v9, v9, s82, -v21
    v_fma_f32 v10, v10, s82, -v21
    v_fma_f32 v11, v11, s82, -v21
    v_exp_f32 v8, v8
    v_exp_f32 v9, v9
    v_exp_f32 v10, v10
    v_exp_f32 v11, v11
    v_mul_f32 v48, v48, v20
    v_mul_f32 v49, v49, v20
    v_mul_f32 v50, v50, v20
    v_mul_f32 v51, v51, v20
    v_mul_f32 v52, v52, v20
    v_mul_f32 v53, v53, v20
    v_mul_f32 v54, v54, v20
    v_mul_f32 v55, v55, v20
    v_cvt_pk_bf16_f32 v22, v8, v9
    v_cvt_pk_bf16_f32 v23, v10, v11
    v_add_f32 v16, v8, v9
    v_add_f32 v17, v10, v11
    v_add_f32 v16, v16, v17
    v_fma_f32 v7, v7, v20, v16
    v_cndmask_b32_e64 v24, 0, v22, s[64:65]
    v_cndmask_b32_e64 v25, 0, v23, s[64:65]
    v_cndmask_b32_e64 v26, 0, v22, s[66:67]
    v_cndmask_b32_e64 v27, 0, v23, s[66:67]
    v_cndmask_b32_e64 v28, 0, v22, s[68:69]
    v_cndmask_b32_e64 v29, 0, v23, s[68:69]
    v_cndmask_b32_e64 v30, 0, v22, s[70:71]
    v_cndmask_b32_e64 v31, 0, v23, s[70:71]
    v_cndmask_b32_e64 v32, 0, v22, s[72:73]
    v_cndmask_b32_e64 v33, 0, v23, s[72:73]
    v_cndmask_b32_e64 v34, 0, v22, s[74:75]
    v_cndmask_b32_e64 v35, 0, v23, s[74:75]
    v_cndmask_b32_e64 v36, 0, v22, s[76:77]
    v_cndmask_b32_e64 v37, 0, v23, s[76:77]
    v_cndmask_b32_e64 v38, 0, v22, s[78:79]
    v_cndmask_b32_e64 v39, 0, v23, s[78:79]
    v_mov_b32 v16, v7
    s_nop 1
    v_permlane16_swap_b32 v7, v16
    v_add_f32 v7, v7, v16
    v_mov_b32 v16, v7
    s_nop 1
    v_permlane32_swap_b32 v7, v16
    v_add_f32 v7, v7, v16
    v_and_b32 v8, 1, v1
    v_lshlrev_b32 v9, 10, v8
    v_lshl_add_u32 v9, v2, 7, v9
    v_lshrrev_b32 v10, 1, v1
    v_lshl_add_u32 v9, v10, 4, v9
    s_and_b32 s9, s3, 1
    s_lshl_b32 s8, s9, 11
    v_add_u32 v9, s8, v9
    v_lshlrev_b32 v8, 5, v8
    s_lshl_b32 s8, s9, 3
    v_add_u32 v8, s8, v8
    s_mov_b64 exec, 3
    ds_write_b64 v8, v[6:7] offset:3072
    s_mov_b64 exec, -1
    s_waitcnt vmcnt(4)
    v_perm_b32 v40, v116, v112, s80
    v_perm_b32 v41, v124, v120, s80
    v_perm_b32 v42, v116, v112, s81
    v_perm_b32 v43, v124, v120, s81
    v_mfma_f32_16x16x16_bf16 v[48:51], v[40:41], v[24:25], v[48:51]
    v_perm_b32 v44, v117, v113, s80
    v_perm_b32 v45, v125, v121, s80
    v_mfma_f32_16x16x16_bf16 v[48:51], v[42:43], v[26:27], v[48:51]
    v_perm_b32 v46, v117, v113, s81
    v_perm_b32 v47, v125, v121, s81
    v_mfma_f32_16x16x16_bf16 v[48:51], v[44:45], v[28:29], v[48:51]
    v_perm_b32 v40, v118, v114, s80
    v_perm_b32 v41, v126, v122, s80
    v_mfma_f32_16x16x16_bf16 v[48:51], v[46:47], v[30:31], v[48:51]
    v_perm_b32 v42, v118, v114, s81
    v_perm_b32 v43, v126, v122, s81
    v_mfma_f32_16x16x16_bf16 v[48:51], v[40:41], v[32:33], v[48:51]
    v_perm_b32 v44, v119, v115, s80
    v_perm_b32 v45, v127, v123, s80
    v_mfma_f32_16x16x16_bf16 v[48:51], v[42:43], v[34:35], v[48:51]
    v_perm_b32 v46, v119, v115, s81
    v_perm_b32 v47, v127, v123, s81
    v_mfma_f32_16x16x16_bf16 v[48:51], v[44:45], v[36:37], v[48:51]
    s_nop 0
    v_mfma_f32_16x16x16_bf16 v[48:51], v[46:47], v[38:39], v[48:51]
    s_waitcnt vmcnt(0)
    v_perm_b32 v40, v132, v128, s80
    v_perm_b32 v41, v140, v136, s80
    v_perm_b32 v42, v132, v128, s81
    v_perm_b32 v43, v140, v136, s81
    v_mfma_f32_16x16x16_bf16 v[52:55], v[40:41], v[24:25], v[52:55]
    v_perm_b32 v44, v133, v129, s80
    v_perm_b32 v45, v141, v137, s80
    v_mfma_f32_16x16x16_bf16 v[52:55], v[42:43], v[26:27], v[52:55]
    v_perm_b32 v46, v133, v129, s81
    v_perm_b32 v47, v141, v137, s81
    v_mfma_f32_16x16x16_bf16 v[52:55], v[44:45], v[28:29], v[52:55]
    v_perm_b32 v40, v134, v130, s80
    v_perm_b32 v41, v142, v138, s80
    v_mfma_f32_16x16x16_bf16 v[52:55], v[46:47], v[30:31], v[52:55]
    v_perm_b32 v42, v134, v130, s81
    v_perm_b32 v43, v142, v138, s81
    v_mfma_f32_16x16x16_bf16 v[52:55], v[40:41], v[32:33], v[52:55]
    v_perm_b32 v44, v135, v131, s80
    v_perm_b32 v45, v143, v139, s80
    v_mfma_f32_16x16x16_bf16 v[52:55], v[42:43], v[34:35], v[52:55]
    v_perm_b32 v46, v135, v131, s81
    v_perm_b32 v47, v143, v139, s81
    v_mfma_f32_16x16x16_bf16 v[52:55], v[44:45], v[36:37], v[52:55]
    s_nop 0
    v_mfma_f32_16x16x16_bf16 v[52:55], v[46:47], v[38:39], v[52:55]
    ds_write_b128 v9, v[48:51] offset:4096
    s_nop 6
    ds_write_b128 v9, v[52:55] offset:4608
    s_waitcnt lgkmcnt(0)
    s_branch L_b2
L_helper:
    s_waitcnt lgkmcnt(0)
    s_load_dword s5, s[38:39], 0
    s_mov_b32 s40, s38
    s_mov_b32 s41, s39
    s_mov_b32 s42, 1572864
    s_mov_b32 s43, 0x20000
    s_barrier
    s_lshr_b32 s8, s3, 1
    s_lshl_b32 s8, s8, 3
    s_lshr_b32 s9, s2, 5
    s_add_u32 s8, s8, s9
    s_lshl_b32 s84, s8, 15
    s_and_b32 s9, s7, 7
    s_lshl_b32 s9, s9, 8
    s_add_u32 s84, s84, s9
    s_and_b32 s9, s3, 1
    s_lshl_b32 s10, s9, 7
    s_add_u32 s84, s84, s10
    s_add_u32 s84, s84, 1048576
    s_add_u32 s85, s84, 16384
    v_lshrrev_b32 v221, 3, v0
    v_and_b32 v222, 7, v0
    v_lshlrev_b32 v212, 11, v221
    v_lshl_add_u32 v212, v222, 4, v212
    v_and_b32 v213, 3, v0
    v_lshlrev_b32 v213, 3, v213
    s_lshl_b32 s10, s3, 6
    v_lshl_add_u32 v214, v222, 3, s10
    v_lshl_add_u32 v214, v2, 1, v214
    v_and_b32 v215, 12, v1
    v_add_u32 v215, v215, v2
    v_lshlrev_b32 v215, 9, v215
    v_add_u32 v215, v215, v213
    v_lshrrev_b32 v216, 1, v1
    v_and_b32 v216, 6, v216
    v_and_b32 v217, 1, v2
    v_or_b32 v216, v216, v217
    v_xor_b32 v216, s3, v216
    v_lshl_add_u32 v215, v216, 5, v215
    v_and_b32 v217, 1, v1
    v_lshlrev_b32 v216, 7, v217
    v_lshl_add_u32 v216, v2, 4, v216
    v_mul_u32_u24 v217, 114688, v217
    v_lshl_add_u32 v217, v2, 4, v217
    s_lshl_b32 s10, s6, 3
    s_add_u32 s10, s10, s3
    s_lshl_b32 s10, s10, 12
    s_lshl_b32 s11, s7, 6
    s_add_u32 s10, s10, s11
    s_add_u32 s87, s10, 524288
    s_lshl_b32 s10, s9, 10
    v_lshl_add_u32 v218, v0, 4, s10
    s_lshl_b32 s10, s9, 5
    v_mov_b32 v219, s10
    s_lshl_b32 s88, s2, 11
    s_add_u32 s88, s88, 1048576
    s_waitcnt lgkmcnt(0)
    s_mul_i32 s4, s5, 0x9E3779B1
    s_add_u32 s4, s4, 0x7F4A7C15
    s_lshr_b32 s56, s4, 8
    s_lshr_b32 s57, s4, 16
    s_lshr_b32 s58, s4, 24
    v_mov_b32 v223, s4
    s_cmp_eq_u32 s3, 6
    s_cbranch_scc1 L_h2
    s_cmp_eq_u32 s3, 7
    s_cbranch_scc1 L_h3
    s_lshr_b32 s13, s7, 3
    s_sub_u32 s13, s7, s13
    s_lshr_b32 s14, s2, 4
    s_add_u32 s14, s14, s2
    s_and_b32 s14, s14, 3
    s_and_b32 s8, s7, 7
    s_cmp_eq_u32 s8, 7
    s_cselect_b32 s14, 0, s14
    s_cmp_eq_u32 s14, 2
    s_cbranch_scc1 L_fjob
    s_cmp_lg_u32 s14, 1
    s_cbranch_scc1 L_h1_skip
    s_cmp_ge_u32 s13, 28
    s_cselect_b32 s44, s30, s28
    s_cselect_b32 s45, s31, s29
    s_cselect_b32 s14, 28, 0
    s_sub_u32 s12, s13, s14
    s_lshl_b32 s8, s12, 7
    s_add_u32 s44, s44, s8
    s_addc_u32 s45, s45, 0
    s_sub_u32 s46, 1605632, s8
    s_mov_b32 s47, 0x20000
    v_lshrrev_b32 v6, 3, v0
    v_mul_u32_u24 v6, 3584, v6
    v_and_b32 v7, 7, v0
    v_lshl_add_u32 v6, v7, 4, v6
    v_lshrrev_b32 v20, 2, v1
    v_lshl_add_u32 v23, v2, 2, v20
    v_lshl_add_u32 v20, v2, 3, v20
    v_and_b32 v21, 3, v1
    v_lshlrev_b32 v21, 3, v21
    v_lshl_add_u32 v20, v20, 7, v21
    v_lshl_add_u32 v23, v23, 7, v21
    s_mul_i32 s10, 0, 224
    v_and_b32 v21, 1, v1
    v_lshlrev_b32 v21, 10, v21
    v_add_u32 v21, s10, v21
    v_lshl_add_u32 v22, v2, 3, v21
    v_lshl_add_u32 v21, v2, 4, v21
    v_mul_u32_u24 v24, 7168, v2
    v_lshl_add_u32 v24, v1, 4, v24
    s_lshl_b32 s8, s14, 9
    s_lshl_b32 s9, s12, 8
    s_add_u32 s8, s8, s9
    s_add_u32 s8, s8, 196608
    v_mov_b32 v104, 0
    v_mov_b32 v105, 0
    v_mov_b32 v106, 0
    v_mov_b32 v107, 0
    v_mov_b32 v108, 0
    v_mov_b32 v109, 0
    v_mov_b32 v110, 0
    v_mov_b32 v111, 0
    v_mov_b32 v112, 0
    v_mov_b32 v113, 0
    v_mov_b32 v114, 0
    v_mov_b32 v115, 0
    v_mov_b32 v116, 0
    v_mov_b32 v117, 0
    v_mov_b32 v118, 0
    v_mov_b32 v119, 0
    v_mov_b32 v120, 0
    v_mov_b32 v121, 0
    v_mov_b32 v122, 0
    v_mov_b32 v123, 0
    v_mov_b32 v124, 0
    v_mov_b32 v125, 0
    v_mov_b32 v126, 0
    v_mov_b32 v127, 0
    v_mov_b32 v128, 0
    v_mov_b32 v129, 0
    v_mov_b32 v130, 0
    v_mov_b32 v131, 0
    v_mov_b32 v132, 0
    v_mov_b32 v133, 0
    v_mov_b32 v134, 0
    v_mov_b32 v135, 0
    s_mov_b32 s15, 0
    s_barrier
    s_mov_b32 s9, 0
    s_mov_b32 m0, 26624
    s_nop 0
    buffer_load_dwordx4 v6, s[44:47], s9 offen sc0 sc1 nt lds
    s_mov_b32 m0, 27648
    s_add_u32 s9, s9, 28672
    buffer_load_dwordx4 v6, s[44:47], s9 offen sc0 sc1 nt lds
    s_mov_b32 m0, 28672
    s_add_u32 s9, s9, 28672
    buffer_load_dwordx4 v6, s[44:47], s9 offen sc0 sc1 nt lds
    s_mov_b32 m0, 29696
    s_add_u32 s9, s9, 28672
    buffer_load_dwordx4 v6, s[44:47], s9 offen sc0 sc1 nt lds
    s_mov_b32 m0, 30720
    s_add_u32 s9, s9, 28672
    buffer_load_dwordx4 v6, s[44:47], s9 offen sc0 sc1 nt lds
    s_mov_b32 m0, 31744
    s_add_u32 s9, s9, 28672
    buffer_load_dwordx4 v6, s[44:47], s9 offen sc0 sc1 nt lds
    s_mov_b32 m0, 32768
    s_add_u32 s9, s9, 28672
    buffer_load_dwordx4 v6, s[44:47], s9 offen sc0 sc1 nt lds
    s_mov_b32 m0, 33792
    s_add_u32 s9, s9, 28672
    buffer_load_dwordx4 v6, s[44:47], s9 offen sc0 sc1 nt lds
    s_mov_b32 m0, 34816
    s_add_u32 s9, s9, 28672
    buffer_load_dwordx4 v6, s[44:47], s9 offen sc0 sc1 nt lds
    s_mov_b32 m0, 35840
    s_add_u32 s9, s9, 28672
    buffer_load_dwordx4 v6, s[44:47], s9 offen sc0 sc1 nt lds
    s_mov_b32 m0, 36864
    s_add_u32 s9, s9, 28672
    buffer_load_dwordx4 v6, s[44:47], s9 offen sc0 sc1 nt lds
    s_mov_b32 m0, 37888
    s_add_u32 s9, s9, 28672
    buffer_load_dwordx4 v6, s[44:47], s9 offen sc0 sc1 nt lds
    s_mov_b32 m0, 38912
    s_add_u32 s9, s9, 28672
    buffer_load_dwordx4 v6, s[44:47], s9 offen sc0 sc1 nt lds
    s_mov_b32 m0, 39936
    s_add_u32 s9, s9, 28672
    buffer_load_dwordx4 v6, s[44:47], s9 offen sc0 sc1 nt lds
    s_barrier
L_gloop:
    s_waitcnt vmcnt(0)
    ds_read_b128 v[32:35], v21 offset:0
    ds_read_b128 v[36:39], v21 offset:64
    ds_read_b128 v[40:43], v21 offset:128
    ds_read_b64 v[44:45], v22 offset:192
    ds_read_b64_tr_b16 v[48:49], v20 offset:26624
    ds_read_b64_tr_b16 v[50:51], v20 offset:27136
    ds_read_b64_tr_b16 v[52:53], v20 offset:30720
    ds_read_b64_tr_b16 v[54:55], v20 offset:31232
    ds_read_b64_tr_b16 v[56:57], v20 offset:34816
    ds_read_b64_tr_b16 v[58:59], v20 offset:35328
    ds_read_b64_tr_b16 v[60:61], v23 offset:38912
    v_cmp_eq_u32 vcc, 1, v2
    s_waitcnt lgkmcnt(7)
    ds_read_b64_tr_b16 v[62:63], v20 offset:26656
    ds_read_b64_tr_b16 v[64:65], v20 offset:27168
    ds_read_b64_tr_b16 v[66:67], v20 offset:30752
    ds_read_b64_tr_b16 v[68:69], v20 offset:31264
    ds_read_b64_tr_b16 v[70:71], v20 offset:34848
    ds_read_b64_tr_b16 v[72:73], v20 offset:35360
    ds_read_b64_tr_b16 v[74:75], v23 offset:38944
    s_waitcnt lgkmcnt(7)
    v_mfma_f32_16x16x16_bf16 v[120:123], v[44:45], v[60:61], v[120:123]
    v_mfma_f32_16x16x32_bf16 v[104:107], v[32:35], v[48:51], v[104:107]
    v_mfma_f32_16x16x32_bf16 v[104:107], v[36:39], v[52:55], v[104:107]
    v_mfma_f32_16x16x32_bf16 v[104:107], v[40:43], v[56:59], v[104:107]
    ds_read_b64_tr_b16 v[76:77], v20 offset:26688
    ds_read_b64_tr_b16 v[78:79], v20 offset:27200
    ds_read_b64_tr_b16 v[80:81], v20 offset:30784
    ds_read_b64_tr_b16 v[82:83], v20 offset:31296
    ds_read_b64_tr_b16 v[84:85], v20 offset:34880
    ds_read_b64_tr_b16 v[86:87], v20 offset:35392
    ds_read_b64_tr_b16 v[88:89], v23 offset:38976
    s_waitcnt lgkmcnt(7)
    v_mfma_f32_16x16x16_bf16 v[124:127], v[44:45], v[74:75], v[124:127]
    v_mfma_f32_16x16x32_bf16 v[108:111], v[32:35], v[62:65], v[108:111]
    v_mfma_f32_16x16x32_bf16 v[108:111], v[36:39], v[66:69], v[108:111]
    v_mfma_f32_16x16x32_bf16 v[108:111], v[40:43], v[70:73], v[108:111]
    ds_read_b64_tr_b16 v[90:91], v20 offset:26720
    ds_read_b64_tr_b16 v[92:93], v20 offset:27232
    ds_read_b64_tr_b16 v[94:95], v20 offset:30816
    ds_read_b64_tr_b16 v[96:97], v20 offset:31328
    ds_read_b64_tr_b16 v[98:99], v20 offset:34912
    ds_read_b64_tr_b16 v[100:101], v20 offset:35424
    ds_read_b64_tr_b16 v[102:103], v23 offset:39008
    s_waitcnt lgkmcnt(7)
    v_mfma_f32_16x16x16_bf16 v[128:131], v[44:45], v[88:89], v[128:131]
    v_mfma_f32_16x16x32_bf16 v[112:115], v[32:35], v[76:79], v[112:115]
    v_mfma_f32_16x16x32_bf16 v[112:115], v[36:39], v[80:83], v[112:115]
    v_mfma_f32_16x16x32_bf16 v[112:115], v[40:43], v[84:87], v[112:115]
    s_waitcnt lgkmcnt(0)
    v_mfma_f32_16x16x16_bf16 v[132:135], v[44:45], v[102:103], v[132:135]
    v_mfma_f32_16x16x32_bf16 v[116:119], v[32:35], v[90:93], v[116:119]
    v_mfma_f32_16x16x32_bf16 v[116:119], v[36:39], v[94:97], v[116:119]
    v_mfma_f32_16x16x32_bf16 v[116:119], v[40:43], v[98:101], v[116:119]
    s_add_u32 s15, s15, 401408
    s_cmp_eq_u32 s15, 1605632
    s_cbranch_scc1 L_gdone
    v_add_u32 v21, 224, v21
    v_add_u32 v22, 224, v22
    s_mov_b32 s9, s15
    s_mov_b32 m0, 26624
    s_nop 0
    buffer_load_dwordx4 v6, s[44:47], s9 offen sc0 sc1 nt lds
    s_mov_b32 m0, 27648
    s_add_u32 s9, s9, 28672
    buffer_load_dwordx4 v6, s[44:47], s9 offen sc0 sc1 nt lds
    s_mov_b32 m0, 28672
    s_add_u32 s9, s9, 28672
    buffer_load_dwordx4 v6, s[44:47], s9 offen sc0 sc1 nt lds
    s_mov_b32 m0, 29696
    s_add_u32 s9, s9, 28672
    buffer_load_dwordx4 v6, s[44:47], s9 offen sc0 sc1 nt lds
    s_mov_b32 m0, 30720
    s_add_u32 s9, s9, 28672
    buffer_load_dwordx4 v6, s[44:47], s9 offen sc0 sc1 nt lds
    s_mov_b32 m0, 31744
    s_add_u32 s9, s9, 28672
    buffer_load_dwordx4 v6, s[44:47], s9 offen sc0 sc1 nt lds
    s_mov_b32 m0, 32768
    s_add_u32 s9, s9, 28672
    buffer_load_dwordx4 v6, s[44:47], s9 offen sc0 sc1 nt lds
    s_mov_b32 m0, 33792
    s_add_u32 s9, s9, 28672
    buffer_load_dwordx4 v6, s[44:47], s9 offen sc0 sc1 nt lds
    s_mov_b32 m0, 34816
    s_add_u32 s9, s9, 28672
    buffer_load_dwordx4 v6, s[44:47], s9 offen sc0 sc1 nt lds
    s_mov_b32 m0, 35840
    s_add_u32 s9, s9, 28672
    buffer_load_dwordx4 v6, s[44:47], s9 offen sc0 sc1 nt lds
    s_mov_b32 m0, 36864
    s_add_u32 s9, s9, 28672
    buffer_load_dwordx4 v6, s[44:47], s9 offen sc0 sc1 nt lds
    s_mov_b32 m0, 37888
    s_add_u32 s9, s9, 28672
    buffer_load_dwordx4 v6, s[44:47], s9 offen sc0 sc1 nt lds
    s_mov_b32 m0, 38912
    s_add_u32 s9, s9, 28672
    buffer_load_dwordx4 v6, s[44:47], s9 offen sc0 sc1 nt lds
    s_mov_b32 m0, 39936
    s_add_u32 s9, s9, 28672
    buffer_load_dwordx4 v6, s[44:47], s9 offen sc0 sc1 nt lds
    s_branch L_gloop
L_gdone:
    v_cndmask_b32 v32, v120, v121, vcc
    v_cndmask_b32 v28, v104, v105, vcc
    v_add_f32 v28, v28, v32
    v_cndmask_b32 v33, v124, v125, vcc
    v_cndmask_b32 v29, v108, v109, vcc
    v_add_f32 v29, v29, v33
    v_cndmask_b32 v34, v128, v129, vcc
    v_cndmask_b32 v30, v112, v113, vcc
    v_add_f32 v30, v30, v34
    v_cndmask_b32 v35, v132, v133, vcc
    v_cndmask_b32 v31, v116, v117, vcc
    v_add_f32 v31, v31, v35
    v_perm_b32 v28, v28, v223, s92
    v_perm_b32 v29, v29, v223, s93
    v_perm_b32 v30, v30, v223, s94
    v_perm_b32 v31, v31, v223, s95
    s_mov_b32 exec_hi, 0
    buffer_store_dwordx4 v[28:31], v24, s[40:43], s8 offen sc1
    s_mov_b64 exec, -1
    s_branch L_b2
L_fjob:
    s_lshr_b32 s12, s13, 2
    s_and_b32 s13, s13, 3
    s_mul_i32 s8, s12, 114688
    s_lshl_b32 s9, s13, 8
    s_add_u32 s8, s8, s9
    s_add_u32 s48, s32, s8
    s_addc_u32 s49, s33, 0
    s_sub_u32 s50, 1605632, s8
    s_mov_b32 s51, 0x20000
    v_mul_u32_u24 v6, 896, v2
    v_lshl_add_u32 v6, v1, 4, v6
    v_lshrrev_b32 v3, 5, v0
    v_mul_u32_u24 v3, 14336, v3
    v_and_b32 v4, 1, v2
    v_mul_u32_u24 v5, 7168, v4
    v_add_u32 v3, v3, v5
    v_lshl_add_u32 v3, v1, 4, v3
    s_lshl_b32 s8, s12, 9
    s_add_u32 s8, s8, 196608
    s_barrier
    s_barrier
    s_mov_b32 s60, 0x40000
L_hpoll:
    buffer_load_dwordx4 v[32:35], v3, s[40:43], s8 offen offset:0 sc1
    buffer_load_dwordx4 v[36:39], v3, s[40:43], s8 offen offset:256 sc1
L_hpoll_w:
    s_waitcnt vmcnt(0)
    v_xor_b32 v5, s4, v32
    v_xor_b32 v7, s4, v36
    v_bitop3_b32 v5, v5, v33, s56 bitop3:0xf6
    v_bitop3_b32 v7, v7, v37, s56 bitop3:0xf6
    v_bitop3_b32 v5, v5, v34, s57 bitop3:0xf6
    v_bitop3_b32 v7, v7, v38, s57 bitop3:0xf6
    v_bitop3_b32 v5, v5, v35, s58 bitop3:0xf6
    v_bitop3_b32 v7, v7, v39, s58 bitop3:0xf6
    v_bitop3_b32 v5, v5, v7, s59 bitop3:0xa8
    v_cmp_ne_u32 vcc, 0, v5
    s_cbranch_vccz L_hpoll_ok
    s_sleep 127
    s_sub_u32 s60, s60, 1
    s_cmp_lg_u32 s60, 0
    s_cbranch_scc1 L_hpoll
L_hpoll_ok:
    v_cvt_pk_bf16_f32 v8, v32, v33
    v_cvt_pk_bf16_f32 v9, v34, v35
    v_cvt_pk_bf16_f32 v10, v36, v37
    v_cvt_pk_bf16_f32 v11, v38, v39
    v_mov_b32 v12, v8
    v_mov_b32 v13, v9
    v_mov_b32 v14, v10
    v_mov_b32 v15, v11
    v_permlane32_swap_b32 v8, v12
    v_permlane32_swap_b32 v9, v13
    v_permlane32_swap_b32 v10, v14
    v_permlane32_swap_b32 v11, v15
    v_lshlrev_b32 v32, 16, v8
    v_and_b32 v33, 0xffff0000, v8
    v_lshlrev_b32 v34, 16, v9
    v_and_b32 v35, 0xffff0000, v9
    v_lshlrev_b32 v36, 16, v10
    v_and_b32 v37, 0xffff0000, v10
    v_lshlrev_b32 v38, 16, v11
    v_and_b32 v39, 0xffff0000, v11
    v_mul_f32 v40, s83, v32
    v_mul_f32 v41, s83, v33
    v_mul_f32 v42, s83, v34
    v_mul_f32 v43, s83, v35
    v_mul_f32 v44, s83, v36
    v_mul_f32 v45, s83, v37
    v_mul_f32 v46, s83, v38
    v_mul_f32 v47, s83, v39
    v_exp_f32 v40, v40
    v_exp_f32 v41, v41
    v_exp_f32 v42, v42
    v_exp_f32 v43, v43
    v_exp_f32 v44, v44
    v_exp_f32 v45, v45
    v_exp_f32 v46, v46
    v_exp_f32 v47, v47
    v_add_f32 v40, 1.0, v40
    v_add_f32 v41, 1.0, v41
    v_add_f32 v42, 1.0, v42
    v_add_f32 v43, 1.0, v43
    v_add_f32 v44, 1.0, v44
    v_add_f32 v45, 1.0, v45
    v_add_f32 v46, 1.0, v46
    v_add_f32 v47, 1.0, v47
    v_rcp_f32 v40, v40
    v_rcp_f32 v41, v41
    v_rcp_f32 v42, v42
    v_rcp_f32 v43, v43
    v_rcp_f32 v44, v44
    v_rcp_f32 v45, v45
    v_rcp_f32 v46, v46
    v_rcp_f32 v47, v47
    v_mul_f32 v32, v32, v40
    v_mul_f32 v33, v33, v41
    v_mul_f32 v34, v34, v42
    v_mul_f32 v35, v35, v43
    v_mul_f32 v36, v36, v44
    v_mul_f32 v37, v37, v45
    v_mul_f32 v38, v38, v46
    v_mul_f32 v39, v39, v47
    v_cvt_pk_bf16_f32 v8, v32, v33
    v_cvt_pk_bf16_f32 v9, v34, v35
    v_cvt_pk_bf16_f32 v10, v36, v37
    v_cvt_pk_bf16_f32 v11, v38, v39
    v_lshlrev_b32 v32, 16, v8
    v_and_b32 v33, 0xffff0000, v8
    v_lshlrev_b32 v40, 16, v12
    v_and_b32 v41, 0xffff0000, v12
    v_lshlrev_b32 v34, 16, v9
    v_and_b32 v35, 0xffff0000, v9
    v_lshlrev_b32 v42, 16, v13
    v_and_b32 v43, 0xffff0000, v13
    v_lshlrev_b32 v36, 16, v10
    v_and_b32 v37, 0xffff0000, v10
    v_lshlrev_b32 v44, 16, v14
    v_and_b32 v45, 0xffff0000, v14
    v_lshlrev_b32 v38, 16, v11
    v_and_b32 v39, 0xffff0000, v11
    v_lshlrev_b32 v46, 16, v15
    v_and_b32 v47, 0xffff0000, v15
    v_mul_f32 v32, v32, v40
    v_mul_f32 v33, v33, v41
    v_mul_f32 v34, v34, v42
    v_mul_f32 v35, v35, v43
    v_mul_f32 v36, v36, v44
    v_mul_f32 v37, v37, v45
    v_mul_f32 v38, v38, v46
    v_mul_f32 v39, v39, v47
    v_cvt_pk_bf16_f32 v8, v32, v33
    v_cvt_pk_bf16_f32 v9, v34, v35
    v_cvt_pk_bf16_f32 v10, v36, v37
    v_cvt_pk_bf16_f32 v11, v38, v39
    v_lshlrev_b32 v7, 8, v4
    v_lshl_add_u32 v7, v1, 1, v7
    ds_write_b16 v7, v8 offset:12288
    ds_write_b16_d16_hi v7, v8 offset:12320
    ds_write_b16 v7, v9 offset:12352
    ds_write_b16_d16_hi v7, v9 offset:12384
    ds_write_b16 v7, v10 offset:12416
    ds_write_b16_d16_hi v7, v10 offset:12448
    ds_write_b16 v7, v11 offset:12480
    ds_write_b16_d16_hi v7, v11 offset:12512
    v_and_b32 v7, 1, v1
    v_lshlrev_b32 v7, 8, v7
    v_lshl_add_u32 v7, v2, 4, v7
    v_lshrrev_b32 v20, 2, v1
    v_lshl_add_u32 v20, v2, 3, v20
    v_lshlrev_b32 v20, 8, v20
    v_add_u32 v20, v20, v213
    v_mov_b32 v64, 0
    v_mov_b32 v65, 0
    v_mov_b32 v66, 0
    v_mov_b32 v67, 0
    v_mov_b32 v68, 0
    v_mov_b32 v69, 0
    v_mov_b32 v70, 0
    v_mov_b32 v71, 0
    v_mov_b32 v72, 0
    v_mov_b32 v73, 0
    v_mov_b32 v74, 0
    v_mov_b32 v75, 0
    v_mov_b32 v76, 0
    v_mov_b32 v77, 0
    v_mov_b32 v78, 0
    v_mov_b32 v79, 0
    v_mov_b32 v80, 0
    v_mov_b32 v81, 0
    v_mov_b32 v82, 0
    v_mov_b32 v83, 0
    v_mov_b32 v84, 0
    v_mov_b32 v85, 0
    v_mov_b32 v86, 0
    v_mov_b32 v87, 0
    v_mov_b32 v88, 0
    v_mov_b32 v89, 0
    v_mov_b32 v90, 0
    v_mov_b32 v91, 0
    v_mov_b32 v92, 0
    v_mov_b32 v93, 0
    v_mov_b32 v94, 0
    v_mov_b32 v95, 0
    s_cmp_eq_u32 s13, 3
    s_cselect_b32 s14, 0x00ff00ff, -1
    s_mov_b32 s10, 0
L_floop:
    s_mov_b32 exec_lo, s14
    s_mov_b32 exec_hi, s14
    s_mov_b32 m0, 57344
    s_nop 0
    buffer_load_dwordx4 v6, s[48:51], s10 offen sc0 sc1 nt lds
    s_add_u32 s10, s10, 3584
    s_mov_b32 m0, 58368
    s_nop 0
    buffer_load_dwordx4 v6, s[48:51], s10 offen sc0 sc1 nt lds
    s_add_u32 s10, s10, 3584
    s_mov_b32 m0, 59392
    s_nop 0
    buffer_load_dwordx4 v6, s[48:51], s10 offen sc0 sc1 nt lds
    s_add_u32 s10, s10, 3584
    s_mov_b32 m0, 60416
    s_nop 0
    buffer_load_dwordx4 v6, s[48:51], s10 offen sc0 sc1 nt lds
    s_add_u32 s10, s10, 3584
    s_mov_b32 m0, 61440
    s_nop 0
    buffer_load_dwordx4 v6, s[48:51], s10 offen sc0 sc1 nt lds
    s_add_u32 s10, s10, 3584
    s_mov_b32 m0, 62464
    s_nop 0
    buffer_load_dwordx4 v6, s[48:51], s10 offen sc0 sc1 nt lds
    s_add_u32 s10, s10, 3584
    s_mov_b32 m0, 63488
    s_nop 0
    buffer_load_dwordx4 v6, s[48:51], s10 offen sc0 sc1 nt lds
    s_add_u32 s10, s10, 3584
    s_mov_b32 m0, 64512
    s_nop 0
    buffer_load_dwordx4 v6, s[48:51], s10 offen sc0 sc1 nt lds
    s_add_u32 s10, s10, 3584
    s_mov_b64 exec, -1
    s_waitcnt vmcnt(0) lgkmcnt(0)
    ds_read_b128 v[8:11], v7 offset:12288
    ds_read_b64_tr_b16 v[32:33], v20 offset:57344
    ds_read_b64_tr_b16 v[34:35], v20 offset:58368
    ds_read_b64_tr_b16 v[36:37], v20 offset:57376
    ds_read_b64_tr_b16 v[38:39], v20 offset:58400
    ds_read_b64_tr_b16 v[40:41], v20 offset:57408
    ds_read_b64_tr_b16 v[42:43], v20 offset:58432
    ds_read_b64_tr_b16 v[44:45], v20 offset:57440
    ds_read_b64_tr_b16 v[46:47], v20 offset:58464
    s_waitcnt lgkmcnt(0)
    ds_read_b64_tr_b16 v[48:49], v20 offset:57472
    ds_read_b64_tr_b16 v[50:51], v20 offset:58496
    ds_read_b64_tr_b16 v[52:53], v20 offset:57504
    ds_read_b64_tr_b16 v[54:55], v20 offset:58528
    ds_read_b64_tr_b16 v[56:57], v20 offset:57536
    ds_read_b64_tr_b16 v[58:59], v20 offset:58560
    ds_read_b64_tr_b16 v[60:61], v20 offset:57568
    ds_read_b64_tr_b16 v[62:63], v20 offset:58592
    s_waitcnt lgkmcnt(0)
    v_mfma_f32_16x16x32_bf16 v[64:67], v[32:35], v[8:11], v[64:67]
    v_mfma_f32_16x16x32_bf16 v[68:71], v[36:39], v[8:11], v[68:71]
    v_mfma_f32_16x16x32_bf16 v[72:75], v[40:43], v[8:11], v[72:75]
    v_mfma_f32_16x16x32_bf16 v[76:79], v[44:47], v[8:11], v[76:79]
    v_mfma_f32_16x16x32_bf16 v[80:83], v[48:51], v[8:11], v[80:83]
    v_mfma_f32_16x16x32_bf16 v[84:87], v[52:55], v[8:11], v[84:87]
    v_mfma_f32_16x16x32_bf16 v[88:91], v[56:59], v[8:11], v[88:91]
    v_mfma_f32_16x16x32_bf16 v[92:95], v[60:63], v[8:11], v[92:95]
    v_add_u32 v7, 64, v7
    s_cmp_lg_u32 s10, 114688
    s_cbranch_scc1 L_floop
    s_lshl_b32 s8, s13, 15
    s_lshl_b32 s9, s12, 6
    s_add_u32 s8, s8, s9
    s_add_u32 s8, s8, 786432
    v_perm_b32 v64, v64, v223, s92
    v_perm_b32 v65, v65, v223, s93
    v_perm_b32 v66, v66, v223, s94
    v_perm_b32 v67, v67, v223, s95
    v_perm_b32 v68, v68, v223, s92
    v_perm_b32 v69, v69, v223, s93
    v_perm_b32 v70, v70, v223, s94
    v_perm_b32 v71, v71, v223, s95
    v_perm_b32 v72, v72, v223, s92
    v_perm_b32 v73, v73, v223, s93
    v_perm_b32 v74, v74, v223, s94
    v_perm_b32 v75, v75, v223, s95
    v_perm_b32 v76, v76, v223, s92
    v_perm_b32 v77, v77, v223, s93
    v_perm_b32 v78, v78, v223, s94
    v_perm_b32 v79, v79, v223, s95
    v_perm_b32 v80, v80, v223, s92
    v_perm_b32 v81, v81, v223, s93
    v_perm_b32 v82, v82, v223, s94
    v_perm_b32 v83, v83, v223, s95
    v_perm_b32 v84, v84, v223, s92
    v_perm_b32 v85, v85, v223, s93
    v_perm_b32 v86, v86, v223, s94
    v_perm_b32 v87, v87, v223, s95
    v_perm_b32 v88, v88, v223, s92
    v_perm_b32 v89, v89, v223, s93
    v_perm_b32 v90, v90, v223, s94
    v_perm_b32 v91, v91, v223, s95
    v_perm_b32 v92, v92, v223, s92
    v_perm_b32 v93, v93, v223, s93
    v_perm_b32 v94, v94, v223, s94
    v_perm_b32 v95, v95, v223, s95
    v_lshlrev_b32 v7, 6, v1
    v_lshl_add_u32 v7, v2, 4, v7
    s_mov_b32 exec_lo, 0x00030003
    s_mov_b32 exec_hi, 0x00030003
    ds_write_b128 v7, v[64:67] offset:57344
    ds_write_b128 v7, v[68:71] offset:57472
    ds_write_b128 v7, v[72:75] offset:57600
    ds_write_b128 v7, v[76:79] offset:57728
    ds_write_b128 v7, v[80:83] offset:57856
    ds_write_b128 v7, v[84:87] offset:57984
    ds_write_b128 v7, v[88:91] offset:58112
    ds_write_b128 v7, v[92:95] offset:58240
    s_mov_b64 exec, -1
    v_lshlrev_b32 v7, 4, v0
    v_bfe_u32 v3, v0, 2, 1
    v_mul_u32_u24 v3, 114688, v3
    v_lshl_add_u32 v3, v221, 12, v3
    v_lshl_add_u32 v3, v213, 1, v3
    s_waitcnt lgkmcnt(0)
    ds_read_b128 v[8:11], v7 offset:57344
    s_cmp_eq_u32 s13, 3
    s_cselect_b32 exec_hi, 0, -1
    s_waitcnt lgkmcnt(0)
    buffer_store_dwordx4 v[8:11], v3, s[40:43], s8 offen sc1
    s_mov_b64 exec, -1
    s_branch L_b2
L_h1_skip:
    s_barrier
    s_barrier
    s_branch L_b2
L_h2:
    s_mul_i32 s8, s7, 57344
    s_lshl_b32 s9, s6, 8
    s_add_u32 s8, s8, s9
    s_add_u32 s44, s24, s8
    s_addc_u32 s45, s25, 0
    s_sub_u32 s46, 3670016, s8
    s_mov_b32 s47, 0x20000
    v_mul_u32_u24 v10, 896, v2
    v_and_b32 v11, 2, v2
    v_xor_b32 v11, v11, v1
    s_cmp_eq_u32 s6, 3
    s_cselect_b32 s11, 8, 16
    v_mov_b32 v12, 0x7fff0000
    v_xor_b32 v13, 0, v11
    v_cmp_gt_u32 vcc, s11, v13
    v_lshl_add_u32 v16, v13, 4, v10
    s_nop 0
    v_cndmask_b32 v16, v12, v16, vcc
    v_xor_b32 v13, 4, v11
    v_cmp_gt_u32 vcc, s11, v13
    v_lshl_add_u32 v17, v13, 4, v10
    s_nop 0
    v_cndmask_b32 v17, v12, v17, vcc
    v_xor_b32 v13, 8, v11
    v_cmp_gt_u32 vcc, s11, v13
    v_lshl_add_u32 v18, v13, 4, v10
    s_nop 0
    v_cndmask_b32 v18, v12, v18, vcc
    v_xor_b32 v13, 12, v11
    v_cmp_gt_u32 vcc, s11, v13
    v_lshl_add_u32 v19, v13, 4, v10
    s_nop 0
    v_cndmask_b32 v19, v12, v19, vcc
    s_barrier
    s_barrier
    s_load_dword s64, s[44:45], 0
    s_load_dword s65, s[44:45], 0xdc80
    s_waitcnt lgkmcnt(0)
    s_barrier
    s_mov_b32 s10, 0
    s_mov_b32 m0, 40960
    s_nop 0
    buffer_load_dwordx4 v16, s[44:47], s10 offen sc0 sc1 nt lds
    s_mov_b32 m0, 41984
    s_add_u32 s10, s10, 3584
    buffer_load_dwordx4 v16, s[44:47], s10 offen sc0 sc1 nt lds
    s_mov_b32 m0, 43008
    s_add_u32 s10, s10, 3584
    buffer_load_dwordx4 v17, s[44:47], s10 offen sc0 sc1 nt lds
    s_mov_b32 m0, 44032
    s_add_u32 s10, s10, 3584
    buffer_load_dwordx4 v17, s[44:47], s10 offen sc0 sc1 nt lds
    s_mov_b32 m0, 45056
    s_add_u32 s10, s10, 3584
    buffer_load_dwordx4 v18, s[44:47], s10 offen sc0 sc1 nt lds
    s_mov_b32 m0, 46080
    s_add_u32 s10, s10, 3584
    buffer_load_dwordx4 v18, s[44:47], s10 offen sc0 sc1 nt lds
    s_mov_b32 m0, 47104
    s_add_u32 s10, s10, 3584
    buffer_load_dwordx4 v19, s[44:47], s10 offen sc0 sc1 nt lds
    s_mov_b32 m0, 48128
    s_add_u32 s10, s10, 3584
    buffer_load_dwordx4 v19, s[44:47], s10 offen sc0 sc1 nt lds
    s_mov_b32 m0, 49152
    s_add_u32 s10, s10, 3584
    buffer_load_dwordx4 v16, s[44:47], s10 offen sc0 sc1 nt lds
    s_mov_b32 m0, 50176
    s_add_u32 s10, s10, 3584
    buffer_load_dwordx4 v16, s[44:47], s10 offen sc0 sc1 nt lds
    s_mov_b32 m0, 51200
    s_add_u32 s10, s10, 3584
    buffer_load_dwordx4 v17, s[44:47], s10 offen sc0 sc1 nt lds
    s_mov_b32 m0, 52224
    s_add_u32 s10, s10, 3584
    buffer_load_dwordx4 v17, s[44:47], s10 offen sc0 sc1 nt lds
    s_mov_b32 m0, 53248
    s_add_u32 s10, s10, 3584
    buffer_load_dwordx4 v18, s[44:47], s10 offen sc0 sc1 nt lds
    s_mov_b32 m0, 54272
    s_add_u32 s10, s10, 3584
    buffer_load_dwordx4 v18, s[44:47], s10 offen sc0 sc1 nt lds
    s_mov_b32 m0, 55296
    s_add_u32 s10, s10, 3584
    buffer_load_dwordx4 v19, s[44:47], s10 offen sc0 sc1 nt lds
    s_mov_b32 m0, 56320
    s_add_u32 s10, s10, 3584
    buffer_load_dwordx4 v19, s[44:47], s10 offen sc0 sc1 nt lds
    s_mov_b64 exec, -1
    s_waitcnt vmcnt(0)
    s_branch L_b3
L_h3:
    s_load_dword s64, s[34:35], 0
    s_barrier
    v_lshlrev_b32 v8, 4, v0
    buffer_load_dwordx4 v[12:15], v8, s[40:43], s88 offen sc1
    buffer_load_dwordx4 v[16:19], v8, s[40:43], s88 offen offset:1024 sc1
    s_barrier
    s_waitcnt lgkmcnt(0)
    s_cmp_lg_u32 s6, 3
    s_cbranch_scc1 L_b2
    s_cmp_ge_u32 s7, 56
    s_cbranch_scc1 L_b2
    s_mov_b32 s44, s16
    s_mov_b32 s45, s17
    s_mov_b32 s46, 1792
    s_mov_b32 s47, 0x20000
    s_lshl_b32 s8, s7, 5
    v_add_u32 v200, s8, v213
    v_lshl_add_u32 v200, v2, 1, v200
    buffer_load_ushort v208, v200, s[44:47], 0 offen
    v_lshlrev_b32 v201, 4, v0
    s_lshl_b32 s8, s7, 12
    s_add_u32 s8, s8, 786432
    v_mov_b32 v32, s4
    v_and_b32 v32, 0xff, v32
    v_mov_b32 v33, s56
    v_and_b32 v33, 0xff, v33
    v_mov_b32 v34, s57
    v_and_b32 v34, 0xff, v34
    v_mov_b32 v35, s58
    v_and_b32 v35, 0xff, v35
    s_mov_b32 s60, 0x40000
L_fpoll:
    s_mov_b32 exec_hi, 0x00ffffff
    buffer_load_dwordx4 v[32:35], v201, s[40:43], s8 offen offset:0 sc1
    s_mov_b32 exec_hi, -1
L_fpoll_w:
    s_waitcnt vmcnt(0)
    v_xor_b32 v5, s4, v32
    v_xor_b32 v7, s56, v33
    v_bitop3_b32 v5, v5, v34, s57 bitop3:0xf6
    v_bitop3_b32 v7, v7, v35, s58 bitop3:0xf6
    v_bitop3_b32 v5, v5, v7, s59 bitop3:0xa8
    v_cmp_ne_u32 vcc, 0, v5
    s_cbranch_vccz L_fpoll_ok
    s_sleep 127
    s_sub_u32 s60, s60, 1
    s_cmp_lg_u32 s60, 0
    s_cbranch_scc1 L_fpoll
L_fpoll_ok:
    s_add_u32 s8, s8, 4294705152
    buffer_load_dwordx4 v[48:51], v201, s[40:43], s8 offen offset:0 sc1
    buffer_load_dwordx4 v[52:55], v201, s[40:43], s8 offen offset:1024 sc1
    buffer_load_dwordx4 v[56:59], v201, s[40:43], s8 offen offset:2048 sc1
    buffer_load_dwordx4 v[60:63], v201, s[40:43], s8 offen offset:3072 sc1
    v_permlane32_swap_b32 v32, v34
    v_permlane32_swap_b32 v33, v35
    v_add_f32 v32, v32, v34
    v_add_f32 v33, v33, v35
    s_nop 1
    v_permlane16_swap_b32 v32, v33
    v_add_f32 v32, v32, v33
    s_nop 1
    v_add_f32_dpp v32, v32, v32 row_ror:4 row_mask:0xf bank_mask:0xf
    s_nop 1
    v_add_f32_dpp v32, v32, v32 row_ror:8 row_mask:0xf bank_mask:0xf
    v_cvt_pk_bf16_f32 v36, v32, v32
    v_lshlrev_b32 v32, 16, v36
    v_mul_f32 v36, s83, v32
    v_exp_f32 v36, v36
    s_nop 0
    v_add_f32 v36, 1.0, v36
    v_rcp_f32 v36, v36
    s_nop 0
    v_mul_f32 v32, v32, v36
    v_cvt_pk_bf16_f32 v36, v32, v32
    v_lshlrev_b32 v202, 16, v36
    v_lshlrev_b32 v206, 16, v208
L_b2:
    s_waitcnt vmcnt(0)
    s_barrier
    s_cmp_lt_u32 s3, 4
    s_cbranch_scc1 L_hop1
    s_cmp_ge_u32 s3, 6
    s_cbranch_scc1 L_wfrag
    ds_read_b128 v[8:11], v219 offset:3072
    ds_read_b128 v[32:35], v218 offset:4096
    ds_read_b128 v[36:39], v218 offset:6144
    s_waitcnt lgkmcnt(2)
    v_max_f32 v24, v8, v10
    v_mul_f32 v24, s82, v24
    v_fma_f32 v8, v8, s82, -v24
    v_fma_f32 v10, v10, s82, -v24
    v_exp_f32 v8, v8
    v_exp_f32 v10, v10
    v_mul_f32 v26, v8, v9
    v_fmac_f32 v26, v10, v11
    v_rcp_f32 v25, v26
    v_log_f32 v26, v26
    s_waitcnt lgkmcnt(0)
    v_mul_f32 v28, v8, v32
    v_mul_f32 v29, v8, v33
    v_mul_f32 v30, v8, v34
    v_mul_f32 v31, v8, v35
    v_fmac_f32 v28, v10, v36
    v_fmac_f32 v29, v10, v37
    v_fmac_f32 v30, v10, v38
    v_fmac_f32 v31, v10, v39
    v_add_f32 v24, v24, v26
    v_mul_f32 v28, v28, v25
    v_mul_f32 v29, v29, v25
    v_mul_f32 v30, v30, v25
    v_mul_f32 v31, v31, v25
    v_lshrrev_b32 v24, v213, v24
    v_perm_b32 v28, v28, v223, s92
    v_perm_b32 v29, v29, v223, s93
    v_perm_b32 v30, v30, v223, s94
    v_perm_b32 v31, v31, v24, s92
    buffer_store_dwordx4 v[28:31], v218, s[40:43], s88 offen sc1
L_wfrag:
    s_branch L_b3
L_hop1:
    s_sleep 16
    s_mov_b32 s60, 0x40000
L_opoll:
    buffer_load_dwordx4 v[40:43], v212, s[40:43], s84 offen sc1
    buffer_load_dwordx4 v[44:47], v212, s[40:43], s85 offen sc1
L_opoll_w:
    s_waitcnt vmcnt(0)
    v_xor_b32 v5, s4, v40
    v_xor_b32 v6, s4, v44
    v_bitop3_b32 v5, v5, v41, s56 bitop3:0xf6
    v_bitop3_b32 v6, v6, v45, s56 bitop3:0xf6
    v_bitop3_b32 v5, v5, v42, s57 bitop3:0xf6
    v_bitop3_b32 v6, v6, v46, s57 bitop3:0xf6
    v_bitop3_b32 v5, v5, v6, s59 bitop3:0xa8
    s_nop 1
    v_or_b32_dpp v5, v5, v5 quad_perm:[1,0,3,2] row_mask:0xf bank_mask:0xf
    s_nop 1
    v_or_b32_dpp v5, v5, v5 quad_perm:[2,3,0,1] row_mask:0xf bank_mask:0xf
    v_cmp_ne_u32 vcc, 0, v5
    s_cbranch_vccz L_opoll_ok
    s_nop 0
    s_mov_b64 exec, vcc
    s_sub_u32 s60, s60, 1
    s_cmp_lg_u32 s60, 0
    s_cbranch_scc1 L_opoll
L_opoll_ok:
    s_mov_b64 exec, -1
    v_and_b32 v32, 0xff, v43
    v_and_b32 v36, 0xff, v47
    v_lshlrev_b32 v32, v213, v32
    v_lshlrev_b32 v36, v213, v36
    s_nop 0
    v_or_b32_dpp v32, v32, v32 quad_perm:[1,0,3,2] row_mask:0xf bank_mask:0xf
    v_or_b32_dpp v36, v36, v36 quad_perm:[1,0,3,2] row_mask:0xf bank_mask:0xf
    s_nop 0
    v_or_b32_dpp v32, v32, v32 quad_perm:[2,3,0,1] row_mask:0xf bank_mask:0xf
    v_or_b32_dpp v36, v36, v36 quad_perm:[2,3,0,1] row_mask:0xf bank_mask:0xf
    v_max_f32 v8, v32, v36
    s_nop 1
    v_max_f32_dpp v8, v8, v8 row_ror:8 row_mask:0xf bank_mask:0xf
    v_mov_b32 v9, v8
    s_nop 1
    v_permlane16_swap_b32 v8, v9
    v_max_f32 v8, v8, v9
    v_mov_b32 v9, v8
    s_nop 1
    v_permlane32_swap_b32 v8, v9
    v_max_f32 v8, v8, v9
    v_sub_f32 v32, v32, v8
    v_sub_f32 v36, v36, v8
    v_exp_f32 v32, v32
    v_exp_f32 v36, v36
    v_mul_f32 v8, v32, v40
    v_mul_f32 v9, v32, v41
    v_mul_f32 v10, v32, v42
    v_mul_f32 v11, v32, v43
    v_add_f32 v12, v32, v36
    v_fmac_f32 v8, v36, v44
    v_fmac_f32 v9, v36, v45
    v_fmac_f32 v10, v36, v46
    v_fmac_f32 v11, v36, v47
    v_mov_b32 v13, v12
    v_permlane32_swap_b32 v8, v10
    v_permlane32_swap_b32 v9, v11
    v_permlane32_swap_b32 v12, v13
    v_add_f32 v8, v8, v10
    v_add_f32 v9, v9, v11
    v_add_f32 v12, v12, v13
    v_mov_b32 v13, v12
    v_permlane16_swap_b32 v8, v9
    s_nop 0
    v_permlane16_swap_b32 v12, v13
    v_add_f32 v8, v8, v9
    v_add_f32 v12, v12, v13
    s_nop 1
    v_add_f32_dpp v12, v12, v12 row_ror:8 row_mask:0xf bank_mask:0xf
    v_add_f32_dpp v8, v8, v8 row_ror:8 row_mask:0xf bank_mask:0xf
    v_rcp_f32 v12, v12
    s_nop 0
    v_mul_f32 v8, v8, v12
    v_cvt_pk_bf16_f32 v8, v8, v8
    s_mov_b32 exec_lo, 0x00ff00ff
    s_mov_b32 exec_hi, 0x00ff00ff
    ds_write_b16 v214, v8 offset:3584
    s_mov_b64 exec, -1
L_b3:
    s_waitcnt lgkmcnt(0)
    s_barrier
    s_cmp_lg_u32 s6, 3
    s_cbranch_scc1 L_proj
    s_cmp_ge_u32 s3, 4
    s_cbranch_scc1 L_final
L_proj:
    ds_read_b128 v[8:11], v216 offset:3584
    ds_read_b64_tr_b16 v[64:65], v215 offset:40960
    ds_read_b64_tr_b16 v[66:67], v215 offset:41216
    ds_read_b128 v[12:15], v216 offset:3648
    ds_read_b64_tr_b16 v[68:69], v215 offset:49152
    ds_read_b64_tr_b16 v[70:71], v215 offset:49408
    s_waitcnt lgkmcnt(3)
    v_mfma_f32_16x16x32_bf16 v[24:27], v[64:67], v[8:11], 0
    s_waitcnt lgkmcnt(0)
    v_mfma_f32_16x16x32_bf16 v[24:27], v[68:71], v[12:15], v[24:27]
    s_nop 7
    v_perm_b32 v28, v24, v223, s92
    v_perm_b32 v29, v25, v223, s93
    v_perm_b32 v30, v26, v223, s94
    v_perm_b32 v31, v27, v223, s95
    s_mov_b32 exec_lo, 0x00030003
    s_mov_b32 exec_hi, 0x00030003
    buffer_store_dwordx4 v[28:31], v217, s[40:43], s87 offen sc1
    s_mov_b64 exec, -1
    s_endpgm
L_final:
    s_cmp_lg_u32 s3, 7
    s_cbranch_scc1 L_fin_end
    s_cmp_ge_u32 s7, 56
    s_cbranch_scc1 L_fin_end
    s_mov_b32 s48, s34
    s_mov_b32 s49, s35
    s_mov_b32 s50, 1792
    s_mov_b32 s51, 0x20000
    s_mov_b32 s80, 0x05040100
    s_lshl_b32 s8, s7, 5
    v_add_u32 v200, s8, v213
    v_lshl_add_u32 v200, v2, 1, v200
    v_lshlrev_b32 v201, 4, v0
    s_lshl_b32 s8, s7, 12
    s_add_u32 s8, s8, 524288
    s_sleep 12
    s_mov_b32 s60, 0x40000
    buffer_load_dwordx4 v[80:83], v201, s[40:43], s8 offen offset:0 sc1
    buffer_load_dwordx4 v[84:87], v201, s[40:43], s8 offen offset:1024 sc1
    buffer_load_dwordx4 v[88:91], v201, s[40:43], s8 offen offset:2048 sc1
    buffer_load_dwordx4 v[92:95], v201, s[40:43], s8 offen offset:3072 sc1
    s_sleep 8
L_spoll:
    buffer_load_dwordx4 v[96:99], v201, s[40:43], s8 offen offset:0 sc1
    buffer_load_dwordx4 v[100:103], v201, s[40:43], s8 offen offset:1024 sc1
    buffer_load_dwordx4 v[104:107], v201, s[40:43], s8 offen offset:2048 sc1
    buffer_load_dwordx4 v[108:111], v201, s[40:43], s8 offen offset:3072 sc1
    s_waitcnt vmcnt(4)
    v_xor_b32 v5, s4, v80
    v_xor_b32 v7, s4, v84
    v_bitop3_b32 v5, v5, v88, s4 bitop3:0xf6
    v_bitop3_b32 v7, v7, v92, s4 bitop3:0xf6
    v_bitop3_b32 v5, v5, v81, s56 bitop3:0xf6
    v_bitop3_b32 v7, v7, v85, s56 bitop3:0xf6
    v_bitop3_b32 v5, v5, v89, s56 bitop3:0xf6
    v_bitop3_b32 v7, v7, v93, s56 bitop3:0xf6
    v_bitop3_b32 v5, v5, v82, s57 bitop3:0xf6
    v_bitop3_b32 v7, v7, v86, s57 bitop3:0xf6
    v_bitop3_b32 v5, v5, v90, s57 bitop3:0xf6
    v_bitop3_b32 v7, v7, v94, s57 bitop3:0xf6
    v_bitop3_b32 v5, v5, v83, s58 bitop3:0xf6
    v_bitop3_b32 v7, v7, v87, s58 bitop3:0xf6
    v_bitop3_b32 v5, v5, v91, s58 bitop3:0xf6
    v_bitop3_b32 v7, v7, v95, s58 bitop3:0xf6
    v_bitop3_b32 v5, v5, v7, s59 bitop3:0xa8
    v_cmp_ne_u32 vcc, 0, v5
    s_cbranch_vccz L_spoll_ok
    buffer_load_dwordx4 v[80:83], v201, s[40:43], s8 offen offset:0 sc1
    buffer_load_dwordx4 v[84:87], v201, s[40:43], s8 offen offset:1024 sc1
    buffer_load_dwordx4 v[88:91], v201, s[40:43], s8 offen offset:2048 sc1
    buffer_load_dwordx4 v[92:95], v201, s[40:43], s8 offen offset:3072 sc1
    s_waitcnt vmcnt(4)
    v_xor_b32 v5, s4, v96
    v_xor_b32 v7, s4, v100
    v_bitop3_b32 v5, v5, v104, s4 bitop3:0xf6
    v_bitop3_b32 v7, v7, v108, s4 bitop3:0xf6
    v_bitop3_b32 v5, v5, v97, s56 bitop3:0xf6
    v_bitop3_b32 v7, v7, v101, s56 bitop3:0xf6
    v_bitop3_b32 v5, v5, v105, s56 bitop3:0xf6
    v_bitop3_b32 v7, v7, v109, s56 bitop3:0xf6
    v_bitop3_b32 v5, v5, v98, s57 bitop3:0xf6
    v_bitop3_b32 v7, v7, v102, s57 bitop3:0xf6
    v_bitop3_b32 v5, v5, v106, s57 bitop3:0xf6
    v_bitop3_b32 v7, v7, v110, s57 bitop3:0xf6
    v_bitop3_b32 v5, v5, v99, s58 bitop3:0xf6
    v_bitop3_b32 v7, v7, v103, s58 bitop3:0xf6
    v_bitop3_b32 v5, v5, v107, s58 bitop3:0xf6
    v_bitop3_b32 v7, v7, v111, s58 bitop3:0xf6
    v_bitop3_b32 v5, v5, v7, s59 bitop3:0xa8
    v_cmp_ne_u32 vcc, 0, v5
    s_cbranch_vccz L_spoll_okb
    s_sub_u32 s60, s60, 1
    s_cmp_lg_u32 s60, 0
    s_cbranch_scc1 L_spoll
L_spoll_okb:
    v_mov_b32 v32, v96
    v_mov_b32 v33, v97
    v_mov_b32 v34, v98
    v_mov_b32 v35, v99
    v_mov_b32 v36, v100
    v_mov_b32 v37, v101
    v_mov_b32 v38, v102
    v_mov_b32 v39, v103
    v_mov_b32 v40, v104
    v_mov_b32 v41, v105
    v_mov_b32 v42, v106
    v_mov_b32 v43, v107
    v_mov_b32 v44, v108
    v_mov_b32 v45, v109
    v_mov_b32 v46, v110
    v_mov_b32 v47, v111
    s_branch L_spoll_done
L_spoll_ok:
    v_mov_b32 v32, v80
    v_mov_b32 v33, v81
    v_mov_b32 v34, v82
    v_mov_b32 v35, v83
    v_mov_b32 v36, v84
    v_mov_b32 v37, v85
    v_mov_b32 v38, v86
    v_mov_b32 v39, v87
    v_mov_b32 v40, v88
    v_mov_b32 v41, v89
    v_mov_b32 v42, v90
    v_mov_b32 v43, v91
    v_mov_b32 v44, v92
    v_mov_b32 v45, v93
    v_mov_b32 v46, v94
    v_mov_b32 v47, v95
L_spoll_done:
    v_add_f32 v32, v32, v36
    v_add_f32 v40, v40, v44
    v_add_f32 v33, v33, v37
    v_add_f32 v41, v41, v45
    v_add_f32 v34, v34, v38
    v_add_f32 v42, v42, v46
    v_add_f32 v35, v35, v39
    v_add_f32 v43, v43, v47
    v_add_f32 v32, v32, v40
    v_add_f32 v33, v33, v41
    v_add_f32 v34, v34, v42
    v_add_f32 v35, v35, v43
    s_nop 0
    v_permlane32_swap_b32 v32, v34
    v_permlane32_swap_b32 v33, v35
    v_add_f32 v32, v32, v34
    v_add_f32 v33, v33, v35
    s_nop 1
    v_permlane16_swap_b32 v32, v33
    v_add_f32 v32, v32, v33
    s_nop 1
    v_add_f32_dpp v32, v32, v32 row_ror:4 row_mask:0xf bank_mask:0xf
    s_nop 1
    v_add_f32_dpp v32, v32, v32 row_ror:8 row_mask:0xf bank_mask:0xf
    v_cvt_pk_bf16_f32 v36, v32, v32
    v_lshlrev_b32 v32, 16, v36
    v_mul_f32 v32, v32, v202
    v_cvt_pk_bf16_f32 v36, v32, v32
    v_lshlrev_b32 v32, 16, v36
    v_add_f32 v32, v32, v206
    v_cvt_pk_bf16_f32 v36, v32, v32
    v_mov_b32 v37, v36
    s_nop 1
    v_permlane16_swap_b32 v36, v37
    v_perm_b32 v36, v37, v36, s80
    v_mov_b32 v37, v36
    s_nop 1
    v_permlane32_swap_b32 v36, v37
    s_mov_b64 exec, 0xf
    buffer_store_dwordx2 v[36:37], v200, s[48:51], 0 offen sc1
    s_cmp_lg_u32 s7, 0
    s_cbranch_scc1 L_fin_end
    s_mov_b64 exec, 1
    v_mov_b32 v7, 0
    buffer_store_dword v223, v7, s[40:43], 0 offen sc1
L_fin_end:
    s_mov_b64 exec, -1
L_end:
    s_endpgm
.fill (20736 - (. - recurrent_scan__gqa_block_cached__swiglu_ffn__decode_kernel)) / 4, 4, 0xbf810000
.section .rodata,"a"
.p2align 6
.amdhsa_kernel recurrent_scan__gqa_block_cached__swiglu_ffn__decode_kernel
  .amdhsa_next_free_vgpr 224
  .amdhsa_next_free_sgpr 100
  .amdhsa_accum_offset 224
  .amdhsa_group_segment_fixed_size 0
  .amdhsa_kernarg_size 96
  .amdhsa_user_sgpr_count 2
  .amdhsa_user_sgpr_kernarg_segment_ptr 1
  .amdhsa_system_sgpr_workgroup_id_x 1
.end_amdhsa_kernel
```
